```python
import torch

def _softmax(x, axis=-1):
    return torch.softmax(x, dim=axis)
def _gelu(x):
    return torch.nn.functional.gelu(x, approximate="tanh")
def _silu(x):
    return torch.nn.functional.silu(x)
def _sigmoid(x):
    return torch.sigmoid(x)
def _layernorm(x, axis=-1, eps=1e-5):
    m = x.mean(dim=axis, keepdim=True)
    v = x.var(dim=axis, keepdim=True, unbiased=False)
    return (x - m) / torch.sqrt(v + eps)
def _scatter_add(tgt, idx, src, axis=0):
    return tgt.clone().index_add_(axis, idx, src)
def _segment_sum(src, seg, n):
    out = torch.zeros((n,) + src.shape[1:], dtype=src.dtype)
    return out.index_add_(0, seg, src)
def _pad(x, pw):
    flat = tuple(v for pair in reversed(pw) for v in pair)
    return torch.nn.functional.pad(x, flat)

kernel_name = 'gated_mix__sliding_block_cached__mixer_channel_mlp__decode'

def setup_inputs():

    _w = (lambda a: (lambda t: t.to(torch.bfloat16) if t.is_floating_point() else t)(torch.as_tensor(a)))
    def _A_setup():
        B, Sq, D = 8, 1, 448
        Hq, Hkv, Sk, Dh = 16, 8, 4096, 256
        assert Hq % Hkv == 0, (Hq, Hkv)
        return {
            "x": _w((lambda *s: torch.randn(*s, dtype=torch.bfloat16) * 0.05)(B, Sq, D)),
            "k_cache": _w((lambda *s: torch.randn(*s, dtype=torch.bfloat16) * 6.4)(B, Hkv, Sk, Dh)),
            "v_cache": _w((lambda *s: torch.randn(*s, dtype=torch.bfloat16) * 0.4)(B, Hkv, Sk, Dh)),
            "wq": _w((lambda *s: torch.randn(*s, dtype=torch.bfloat16) * 6.4)(D, Hq * Dh) * (D ** -0.5)),
            "wo": _w((lambda *s: torch.randn(*s, dtype=torch.bfloat16) * 0.4)(Hq * Dh, D) * ((Hq * Dh) ** -0.5)),
        }
    _A_in = _A_setup()

    def _B_setup():
        B, S, D, F = 8, 1, 448, 1792
        return {
            "x": _w((lambda *s: torch.randn(*s, dtype=torch.bfloat16) * 0.05)(B, S, D)),
            "w1": _w((lambda *s: torch.randn(*s, dtype=torch.bfloat16) * 0.8)(D, F) * (D ** -0.5)),
            "b1": _w((lambda *s: torch.randn(*s, dtype=torch.bfloat16) * 0.8)(F)),
            "w2": _w((lambda *s: torch.randn(*s, dtype=torch.bfloat16) * 0.05)(F, D) * (F ** -0.5)),
            "b2": _w((lambda *s: torch.randn(*s, dtype=torch.bfloat16) * 0.05)(D)),
        }
    _B_in = _B_setup()

    return {
        "A_x": _A_in["x"],
        "A_k_cache": _A_in["k_cache"],
        "A_v_cache": _A_in["v_cache"],
        "A_wq": _A_in["wq"],
        "A_wo": _A_in["wo"],
        "B_x": _B_in["x"],
        "B_w1": _B_in["w1"],
        "B_b1": _B_in["b1"],
        "B_w2": _B_in["w2"],
        "B_b2": _B_in["b2"],
        "gate_w": _w((lambda *s: torch.randn(*s, dtype=torch.bfloat16) * 0.05)(448) * 16.0),
    }

def reference(A_x, A_k_cache, A_v_cache, A_wq, A_wo, B_x, B_w1, B_b1, B_w2, B_b2, gate_w):
    def _A_ref(x, k_cache, v_cache, wq, wo):
        B, Sq, D = x.shape
        Hq, Dh = 16, 256
        Hkv, Sk = k_cache.shape[1], k_cache.shape[2]
        W = min(4096, max(256, Sk // 4))
        rep = Hq // Hkv
        q = (lambda x, *d: x.permute(*d))((x @ wq).reshape(B, Sq, Hq, Dh), 0, 2, 1, 3)
        k = (lambda x, n, axis: torch.repeat_interleave(x, n, dim=axis))(k_cache[:, :, Sk - W:, :], rep, axis=1)
        v = (lambda x, n, axis: torch.repeat_interleave(x, n, dim=axis))(v_cache[:, :, Sk - W:, :], rep, axis=1)
        scores = torch.einsum("bhqd,bhkd->bhqk", q, k) * (Dh ** -0.5)
        p = _softmax(scores, axis=-1)
        o = torch.einsum("bhqk,bhkd->bhqd", p, v)
        return (lambda x, *d: x.permute(*d))(o, 0, 2, 1, 3).reshape(B, Sq, Hq * Dh) @ wo

    def _B_ref(x, w1, b1, w2, b2):
        y = _layernorm(x, axis=-1)
        h = _gelu(torch.einsum("bsd,df->bsf", y, w1) + b1)
        return torch.einsum("bsf,fd->bsd", h, w2) + b2

    x = A_x
    g = _sigmoid((x * gate_w).sum(-1, keepdims=True))
    a = _A_ref(x, A_k_cache, A_v_cache, A_wq, A_wo)
    b = _B_ref(x, B_w1, B_b1, B_w2, B_b2)
    return g * a + (1 - g) * b
```

```asm
; @launch grid=(256,1,1) block=(512,1,1) lds=83520
.amdgcn_target "amdgcn-amd-amdhsa--gfx950"
.text
.globl gated_mix__sliding_block_cached__mixer_channel_mlp__decode_kernel
.p2align 8
.type gated_mix__sliding_block_cached__mixer_channel_mlp__decode_kernel,@function
gated_mix__sliding_block_cached__mixer_channel_mlp__decode_kernel:
    s_cmp_ge_u32 s2, 256
    s_cbranch_scc1 L_end
    s_load_dwordx16 s[16:31], s[0:1], 0
    s_load_dwordx8 s[32:39], s[0:1], 64
    s_load_dwordx4 s[40:43], s[0:1], 96
    v_lshrrev_b32 v1, 6, v0
    v_and_b32 v0, 63, v0
    v_readfirstlane_b32 s3, v1
    s_lshr_b32 s4, s2, 5
    s_bfe_u32 s5, s2, 0x30002
    s_and_b32 s6, s2, 3
    s_and_b32 s7, s2, 31
    s_and_b32 s8, s2, 7
    s_lshr_b32 s9, s2, 3
    v_and_b32 v2, 15, v0
    v_lshrrev_b32 v3, 4, v0
    v_mov_b32 v4, 83456
    v_mov_b32 v5, 1
    s_cmp_ge_u32 s3, 4
    s_cbranch_scc1 L_service
    s_lshl_b32 s10, s4, 3
    s_add_u32 s10, s10, s5
    s_lshl_b32 s11, s10, 21
    s_add_u32 s11, s11, 1572864
    s_lshl_b32 s12, s6, 15
    s_lshl_b32 s13, s3, 13
    s_add_u32 s12, s12, s13
    s_sub_u32 s14, 524288, s12
    s_add_u32 s12, s12, s11
    s_mov_b32 s64, 0
    s_mov_b32 s65, 0x20000
    s_mov_b32 s66, 0x40000
    s_mov_b32 s67, 0x60000
    v_bfe_u32 v6, v0, 2, 2
    v_lshlrev_b32 v6, 11, v6
    v_lshl_add_u32 v6, v3, 6, v6
    v_and_b32 v7, 3, v0
    v_lshl_add_u32 v6, v7, 4, v6
    s_waitcnt lgkmcnt(0)
    s_add_u32 s48, s18, s12
    s_addc_u32 s49, s19, 0
    s_mov_b32 s50, s14
    s_mov_b32 s51, 0x20000
    buffer_load_dwordx4 v[64:67], v6, s[48:51], s64 offen offset:0 nt
    buffer_load_dwordx4 v[68:71], v6, s[48:51], s64 offen offset:256 nt
    s_branch L_bulk_main
L_service:
    s_setprio 2
    s_mov_b32 s14, 0x00ff00ff
    s_mov_b32 s15, 0x00ff00ff
    v_cmp_gt_u32 vcc, 8, v2
    v_lshrrev_b32 v6, 2, v2
    v_lshl_add_u32 v6, v3, 3, v6
    v_and_b32 v7, 3, v2
    v_lshlrev_b32 v7, 3, v7
    v_mul_u32_u24 v8, 896, v6
    v_add_u32 v8, v8, v7
    v_lshl_add_u32 v6, v6, 5, v7
    s_cmp_eq_u32 s3, 7
    s_cbranch_scc1 L_s3
    s_cmp_eq_u32 s3, 6
    s_cbranch_scc1 L_s2_pre
    s_cmp_eq_u32 s3, 5
    s_cbranch_scc1 L_s1
L_s0:
    v_lshrrev_b32 v9, 2, v0
    v_and_b32 v10, 3, v0
    v_lshlrev_b32 v10, 4, v10
    v_lshl_add_u32 v11, v9, 13, v10
    s_lshr_b32 s11, s9, 1
    s_and_b32 s46, s11, 6
    s_cmp_eq_u32 s46, 6
    s_cselect_b32 s46, 8, 0
    s_xor_b32 s11, s11, s46
    s_lshl_b32 s10, s8, 10
    s_lshl_b32 s11, s11, 6
    s_add_u32 s10, s10, s11
    s_sub_u32 s11, 3670016, s10
    s_mov_b32 s12, 0
    s_mov_b32 m0, 16384
    s_waitcnt lgkmcnt(0)
    s_bitcmp1_b32 s9, 0
    s_cbranch_scc1 L_s0_noq1
    s_add_u32 s48, s22, s10
    s_addc_u32 s49, s23, 0
    s_mov_b32 s50, s11
    s_mov_b32 s51, 0x20000
    s_mov_b32 s13, 28
L_dma_27:
    buffer_load_dwordx4 v11, s[48:51], s12 offen nt lds
    s_add_u32 m0, m0, 1024
    s_add_u32 s12, s12, 131072
    s_sub_u32 s13, s13, 1
    s_cmp_lg_u32 s13, 0
    s_cbranch_scc1 L_dma_27
L_s0_noq1:
    s_load_dword s44, s[42:43], 0
    s_mov_b32 s60, s42
    s_mov_b32 s61, s43
    s_mov_b32 s62, 0x800000
    s_mov_b32 s63, 0x20000
    s_barrier
    s_branch L_s0_main
L_s3:
    v_lshlrev_b32 v9, 4, v0
    s_mov_b32 m0, 52224
    s_mov_b32 s12, 0
    s_waitcnt lgkmcnt(0)
    s_load_dword s44, s[42:43], 0
    s_mov_b32 s60, s42
    s_mov_b32 s61, s43
    s_mov_b32 s62, 0x800000
    s_mov_b32 s63, 0x20000
    s_mov_b32 s48, s16
    s_mov_b32 s49, s17
    s_mov_b32 s50, 7168
    s_mov_b32 s51, 0x20000
    buffer_load_dwordx4 v9, s[48:51], s12 offen offset:0 lds
    buffer_load_dwordx4 v9, s[48:51], s12 offen offset:1024 lds
    buffer_load_dwordx4 v9, s[48:51], s12 offen offset:2048 lds
    buffer_load_dwordx4 v9, s[48:51], s12 offen offset:3072 lds
    s_mov_b32 m0, 56320
    s_mov_b32 s12, 4096
    buffer_load_dwordx4 v9, s[48:51], s12 offen offset:0 lds
    buffer_load_dwordx4 v9, s[48:51], s12 offen offset:1024 lds
    buffer_load_dwordx4 v9, s[48:51], s12 offen offset:2048 lds
    s_barrier
    s_branch L_s3_main
L_s2_pre:
    v_lshlrev_b32 v9, 2, v0
    v_add_u32 v9, 83456, v9
    v_mov_b32 v10, 0
    s_mov_b64 exec, 0xffff
    ds_write_b32 v9, v10
    s_mov_b64 exec, -1
    v_lshrrev_b32 v9, 1, v0
    v_and_b32 v10, 1, v0
    v_lshlrev_b32 v10, 4, v10
    v_mul_u32_u24 v14, 3584, v9
    v_add_u32 v14, v14, v10
    v_lshlrev_b32 v15, 3, v3
    s_lshr_b32 s10, s9, 1
    s_mul_i32 s11, s8, 14
    s_add_u32 s10, s10, s11
    s_mov_b32 s69, s10
    s_lshl_b32 s10, s10, 5
    s_sub_u32 s11, 1605632, s10
    s_mov_b32 s12, 0
    s_mov_b32 m0, 30720
    s_waitcnt lgkmcnt(0)
    s_bitcmp0_b32 s9, 0
    s_cbranch_scc1 L_s2_nom1
    s_cmp_ge_u32 s9, 28
    s_cbranch_scc1 L_s2_nom1
    s_add_u32 s56, s28, s10
    s_addc_u32 s57, s29, 0
    s_mov_b32 s58, s11
    s_mov_b32 s59, 0x20000
    s_mov_b32 s13, 14
L_dma_44:
    buffer_load_dwordx4 v14, s[56:59], s12 offen nt lds
    s_add_u32 m0, m0, 1024
    s_add_u32 s12, s12, 114688
    s_sub_u32 s13, s13, 1
    s_cmp_lg_u32 s13, 0
    s_cbranch_scc1 L_dma_44
    s_mov_b32 s64, s30
    s_mov_b32 s65, s31
    s_mov_b32 s66, 3584
    s_mov_b32 s67, 0x20000
    buffer_load_dwordx2 v[24:25], v15, s[64:67], s10 offen
L_s2_nom1:
    s_load_dword s44, s[42:43], 0
    s_mov_b32 s60, s42
    s_mov_b32 s61, s43
    s_mov_b32 s62, 0x800000
    s_mov_b32 s63, 0x20000
    s_barrier
    s_branch L_s2_main
L_s1:
    s_waitcnt lgkmcnt(0)
    s_load_dword s44, s[42:43], 0
    s_mov_b32 s60, s42
    s_mov_b32 s61, s43
    s_mov_b32 s62, 0x800000
    s_mov_b32 s63, 0x20000
    s_getreg_b32 s67, hwreg(HW_REG_XCC_ID)
    v_mov_b32 v13, 2147418112
    v_mov_b32 v18, 0
    v_cmp_eq_u32 vcc, 0, v0
    s_nop 1
    v_cndmask_b32 v18, v13, v18, vcc
    s_lshl_b32 s10, s8, 9
    s_lshl_b32 s11, s9, 3
    s_add_u32 s11, s11, s10
    s_add_u32 s11, s11, 2228224
    s_waitcnt lgkmcnt(0)
    s_mul_i32 s44, s44, 1664525
    s_add_u32 s44, s44, 1013904223
    v_mov_b32 v16, s67
    v_mov_b32 v17, s44
    buffer_store_dwordx2 v[16:17], v18, s[60:63], s11 offen sc1
    s_barrier
    s_branch L_s1_main
L_bulk_main:
    s_load_dword s44, s[42:43], 0
    s_mov_b32 s60, s42
    s_mov_b32 s61, s43
    s_mov_b32 s62, 0x800000
    s_mov_b32 s63, 0x20000
    s_lshl_b32 s12, s3, 15
    s_lshl_b32 s13, s6, 7
    s_add_u32 s12, s12, s13
    s_sub_u32 s14, 524288, s12
    s_add_u32 s12, s12, s11
    s_add_u32 s52, s20, s12
    s_addc_u32 s53, s21, 0
    s_mov_b32 s54, s14
    s_mov_b32 s55, 0x20000
    v_lshrrev_b32 v7, 3, v0
    v_lshlrev_b32 v7, 12, v7
    v_and_b32 v8, 7, v0
    v_lshl_add_u32 v7, v8, 4, v7
    v_lshlrev_b32 v9, 11, v3
    v_lshl_add_u32 v9, v2, 3, v9
    s_lshl_b32 s15, s10, 13
    s_lshl_b32 s12, s6, 9
    s_add_u32 s15, s15, s12
    s_lshl_b32 s12, s3, 7
    s_add_u32 s15, s15, s12
    s_add_u32 s15, s15, 196608
    v_bfe_u32 v10, v0, 2, 1
    v_lshlrev_b32 v10, 9, v10
    v_lshl_add_u32 v10, v3, 6, v10
    v_and_b32 v11, 3, v0
    v_lshl_add_u32 v10, v11, 4, v10
    v_add_u32 v10, 66688, v10
    v_bfe_u32 v11, v0, 1, 1
    v_lshlrev_b32 v11, 11, v11
    v_lshl_add_u32 v11, v3, 5, v11
    v_and_b32 v12, 1, v0
    v_lshl_add_u32 v11, v12, 4, v11
    s_lshl_b32 s12, s3, 7
    s_add_u32 s12, s12, 67712
    v_add_u32 v11, s12, v11
    v_and_b32 v12, 7, v0
    v_lshlrev_b32 v12, 5, v12
    s_lshl_b32 s12, s3, 9
    s_add_u32 s12, s12, 71808
    v_add_u32 v12, s12, v12
    v_lshlrev_b32 v14, 2, v0
    s_lshl_b32 s12, s3, 8
    s_add_u32 s12, s12, 82304
    v_add_u32 v14, s12, v14
    s_mov_b32 s68, 0x05040100
    s_mov_b32 s69, 0x07060302
    s_mov_b32 s47, 0
    s_mov_b32 s16, 0xffff0000
    s_mov_b32 s17, 0
    s_mov_b32 s18, 0
    s_mov_b32 s19, 0x0000ffff
    s_mov_b32 s20, 0
    s_mov_b32 s21, 0xffff0000
    s_mov_b32 s22, 0x22222222
    s_mov_b32 s23, 0x22222222
    s_mov_b32 s24, 0x44444444
    s_mov_b32 s25, 0x44444444
    s_mov_b32 s26, 0x88888888
    s_mov_b32 s27, 0x88888888
    s_barrier
    buffer_load_dwordx4 v[72:75], v6, s[48:51], s64 offen offset:512 nt
    buffer_load_dwordx4 v[76:79], v6, s[48:51], s64 offen offset:768 nt
    buffer_load_dwordx4 v[80:83], v6, s[48:51], s64 offen offset:1024 nt
    buffer_load_dwordx4 v[84:87], v6, s[48:51], s64 offen offset:1280 nt
    buffer_load_dwordx4 v[88:91], v6, s[48:51], s64 offen offset:1536 nt
    buffer_load_dwordx4 v[92:95], v6, s[48:51], s64 offen offset:1792 nt
    buffer_load_dwordx4 v[96:99], v6, s[48:51], s65 offen offset:0 nt
    s_waitcnt vmcnt(8)
    buffer_load_dwordx4 v[100:103], v6, s[48:51], s65 offen offset:256 nt
    s_waitcnt vmcnt(8)
    buffer_load_dwordx4 v[104:107], v6, s[48:51], s65 offen offset:512 nt
    s_waitcnt vmcnt(8)
    buffer_load_dwordx4 v[108:111], v6, s[48:51], s65 offen offset:768 nt
    s_waitcnt vmcnt(8)
    buffer_load_dwordx4 v[112:115], v6, s[48:51], s65 offen offset:1024 nt
    s_waitcnt vmcnt(8)
    buffer_load_dwordx4 v[116:119], v6, s[48:51], s65 offen offset:1280 nt
    s_waitcnt vmcnt(8)
    buffer_load_dwordx4 v[120:123], v6, s[48:51], s65 offen offset:1536 nt
    s_waitcnt vmcnt(8)
    buffer_load_dwordx4 v[124:127], v6, s[48:51], s65 offen offset:1792 nt
    s_waitcnt vmcnt(8)
    buffer_load_dwordx4 v[128:131], v6, s[48:51], s66 offen offset:0 nt
    s_waitcnt vmcnt(8)
    buffer_load_dwordx4 v[132:135], v6, s[48:51], s66 offen offset:256 nt
    s_waitcnt vmcnt(8)
    buffer_load_dwordx4 v[136:139], v6, s[48:51], s66 offen offset:512 nt
    s_waitcnt vmcnt(8)
    buffer_load_dwordx4 v[140:143], v6, s[48:51], s66 offen offset:768 nt
    s_waitcnt vmcnt(8)
    buffer_load_dwordx4 v[144:147], v6, s[48:51], s66 offen offset:1024 nt
    s_waitcnt vmcnt(8)
    buffer_load_dwordx4 v[148:151], v6, s[48:51], s66 offen offset:1280 nt
    s_waitcnt vmcnt(8)
    buffer_load_dwordx4 v[152:155], v6, s[48:51], s66 offen offset:1536 nt
    s_waitcnt vmcnt(8)
    buffer_load_dwordx4 v[156:159], v6, s[48:51], s66 offen offset:1792 nt
    s_waitcnt vmcnt(8)
    buffer_load_dwordx4 v[160:163], v6, s[48:51], s67 offen offset:0 nt
    s_waitcnt vmcnt(8)
    buffer_load_dwordx4 v[164:167], v6, s[48:51], s67 offen offset:256 nt
    s_waitcnt vmcnt(8)
    buffer_load_dwordx4 v[168:171], v6, s[48:51], s67 offen offset:512 nt
    s_waitcnt vmcnt(8)
    buffer_load_dwordx4 v[172:175], v6, s[48:51], s67 offen offset:768 nt
    s_waitcnt vmcnt(8)
    ds_add_u32 v4, v5 offset:20
    buffer_load_dwordx4 v[176:179], v6, s[48:51], s67 offen offset:1024 nt
    s_waitcnt vmcnt(8)
    buffer_load_dwordx4 v[180:183], v6, s[48:51], s67 offen offset:1280 nt
    s_waitcnt vmcnt(8)
    buffer_load_dwordx4 v[184:187], v6, s[48:51], s67 offen offset:1536 nt
    s_waitcnt vmcnt(8)
    buffer_load_dwordx4 v[188:191], v6, s[48:51], s67 offen offset:1792 nt
    s_waitcnt vmcnt(5)
    buffer_load_dwordx4 v[192:195], v7, s[52:55], s64 offen offset:0 nt
    s_waitcnt vmcnt(5)
    buffer_load_dwordx4 v[196:199], v7, s[52:55], s64 offen offset:512 nt
    s_waitcnt vmcnt(5)
    buffer_load_dwordx4 v[200:203], v7, s[52:55], s64 offen offset:1024 nt
    s_waitcnt vmcnt(5)
    buffer_load_dwordx4 v[204:207], v7, s[52:55], s64 offen offset:1536 nt
    s_waitcnt vmcnt(5)
    buffer_load_dwordx4 v[208:211], v7, s[52:55], s64 offen offset:2048 nt
    s_waitcnt vmcnt(5)
    buffer_load_dwordx4 v[212:215], v7, s[52:55], s64 offen offset:2560 nt
    s_waitcnt vmcnt(5)
    s_waitcnt lgkmcnt(0)
    s_mul_i32 s44, s44, 1664525
    s_add_u32 s44, s44, 1013904223
    v_mov_b32 v229, s44
    s_mov_b32 s45, 0x100000
L_fl_1:
    ds_read_b32 v13, v4 offset:0
    s_waitcnt lgkmcnt(0)
    v_readfirstlane_b32 s46, v13
    s_nop 1
    s_cmp_ge_u32 s46, 1
    s_cbranch_scc1 L_fld_2
    s_sub_u32 s45, s45, 1
    s_cmp_lg_u32 s45, 0
    s_cbranch_scc1 L_fl_1
L_fld_2:
    ds_read_b128 v[32:35], v10 offset:0
    ds_read_b128 v[36:39], v10 offset:256
    s_waitcnt lgkmcnt(0)
    s_waitcnt vmcnt(30)
    v_mfma_f32_16x16x32_bf16 v[40:43], v[32:35], v[64:67], 0
    v_mfma_f32_16x16x32_bf16 v[44:47], v[32:35], v[72:75], 0
    v_mfma_f32_16x16x32_bf16 v[48:51], v[32:35], v[80:83], 0
    v_mfma_f32_16x16x32_bf16 v[52:55], v[32:35], v[88:91], 0
    v_mfma_f32_16x16x32_bf16 v[40:43], v[36:39], v[68:71], v[40:43]
    v_mfma_f32_16x16x32_bf16 v[44:47], v[36:39], v[76:79], v[44:47]
    v_mfma_f32_16x16x32_bf16 v[48:51], v[36:39], v[84:87], v[48:51]
    v_mfma_f32_16x16x32_bf16 v[52:55], v[36:39], v[92:95], v[52:55]
    s_nop 4
    v_mov_b32_dpp v56, v40 quad_perm:[0,0,0,0] row_mask:0xf bank_mask:0xf
    v_mov_b32_dpp v57, v44 quad_perm:[0,0,0,0] row_mask:0xf bank_mask:0xf
    v_mov_b32_dpp v58, v48 quad_perm:[0,0,0,0] row_mask:0xf bank_mask:0xf
    v_mov_b32_dpp v59, v52 quad_perm:[0,0,0,0] row_mask:0xf bank_mask:0xf
    v_add_f32_dpp v56, v41, v56 quad_perm:[1,1,1,1] row_mask:0xf bank_mask:0xf
    v_add_f32_dpp v57, v45, v57 quad_perm:[1,1,1,1] row_mask:0xf bank_mask:0xf
    v_add_f32_dpp v58, v49, v58 quad_perm:[1,1,1,1] row_mask:0xf bank_mask:0xf
    v_add_f32_dpp v59, v53, v59 quad_perm:[1,1,1,1] row_mask:0xf bank_mask:0xf
    v_add_f32_dpp v56, v42, v56 quad_perm:[2,2,2,2] row_mask:0xf bank_mask:0xf
    v_add_f32_dpp v57, v46, v57 quad_perm:[2,2,2,2] row_mask:0xf bank_mask:0xf
    v_add_f32_dpp v58, v50, v58 quad_perm:[2,2,2,2] row_mask:0xf bank_mask:0xf
    v_add_f32_dpp v59, v54, v59 quad_perm:[2,2,2,2] row_mask:0xf bank_mask:0xf
    v_add_f32_dpp v56, v43, v56 quad_perm:[3,3,3,3] row_mask:0xf bank_mask:0xf
    v_add_f32_dpp v57, v47, v57 quad_perm:[3,3,3,3] row_mask:0xf bank_mask:0xf
    v_add_f32_dpp v58, v51, v58 quad_perm:[3,3,3,3] row_mask:0xf bank_mask:0xf
    v_add_f32_dpp v59, v55, v59 quad_perm:[3,3,3,3] row_mask:0xf bank_mask:0xf
    v_cndmask_b32 v56, v56, v57, s[22:23]
    v_cndmask_b32 v56, v56, v58, s[24:25]
    v_cndmask_b32 v56, v56, v59, s[26:27]
    v_mov_b32 v57, v56
    s_nop 1
    v_permlane16_swap_b32 v56, v57
    v_cvt_pk_bf16_f32 v224, v56, v57
    buffer_load_dwordx4 v[216:219], v7, s[52:55], s64 offen offset:3072 nt
    s_waitcnt vmcnt(23)
    v_mfma_f32_16x16x32_bf16 v[40:43], v[32:35], v[96:99], 0
    v_mfma_f32_16x16x32_bf16 v[44:47], v[32:35], v[104:107], 0
    v_mfma_f32_16x16x32_bf16 v[48:51], v[32:35], v[112:115], 0
    v_mfma_f32_16x16x32_bf16 v[52:55], v[32:35], v[120:123], 0
    v_mfma_f32_16x16x32_bf16 v[40:43], v[36:39], v[100:103], v[40:43]
    v_mfma_f32_16x16x32_bf16 v[44:47], v[36:39], v[108:111], v[44:47]
    v_mfma_f32_16x16x32_bf16 v[48:51], v[36:39], v[116:119], v[48:51]
    v_mfma_f32_16x16x32_bf16 v[52:55], v[36:39], v[124:127], v[52:55]
    s_nop 4
    v_mov_b32_dpp v56, v40 quad_perm:[0,0,0,0] row_mask:0xf bank_mask:0xf
    v_mov_b32_dpp v57, v44 quad_perm:[0,0,0,0] row_mask:0xf bank_mask:0xf
    v_mov_b32_dpp v58, v48 quad_perm:[0,0,0,0] row_mask:0xf bank_mask:0xf
    v_mov_b32_dpp v59, v52 quad_perm:[0,0,0,0] row_mask:0xf bank_mask:0xf
    v_add_f32_dpp v56, v41, v56 quad_perm:[1,1,1,1] row_mask:0xf bank_mask:0xf
    v_add_f32_dpp v57, v45, v57 quad_perm:[1,1,1,1] row_mask:0xf bank_mask:0xf
    v_add_f32_dpp v58, v49, v58 quad_perm:[1,1,1,1] row_mask:0xf bank_mask:0xf
    v_add_f32_dpp v59, v53, v59 quad_perm:[1,1,1,1] row_mask:0xf bank_mask:0xf
    v_add_f32_dpp v56, v42, v56 quad_perm:[2,2,2,2] row_mask:0xf bank_mask:0xf
    v_add_f32_dpp v57, v46, v57 quad_perm:[2,2,2,2] row_mask:0xf bank_mask:0xf
    v_add_f32_dpp v58, v50, v58 quad_perm:[2,2,2,2] row_mask:0xf bank_mask:0xf
    v_add_f32_dpp v59, v54, v59 quad_perm:[2,2,2,2] row_mask:0xf bank_mask:0xf
    v_add_f32_dpp v56, v43, v56 quad_perm:[3,3,3,3] row_mask:0xf bank_mask:0xf
    v_add_f32_dpp v57, v47, v57 quad_perm:[3,3,3,3] row_mask:0xf bank_mask:0xf
    v_add_f32_dpp v58, v51, v58 quad_perm:[3,3,3,3] row_mask:0xf bank_mask:0xf
    v_add_f32_dpp v59, v55, v59 quad_perm:[3,3,3,3] row_mask:0xf bank_mask:0xf
    v_cndmask_b32 v56, v56, v57, s[22:23]
    v_cndmask_b32 v56, v56, v58, s[24:25]
    v_cndmask_b32 v56, v56, v59, s[26:27]
    v_mov_b32 v57, v56
    s_nop 1
    v_permlane16_swap_b32 v56, v57
    v_cvt_pk_bf16_f32 v225, v56, v57
    buffer_load_dwordx4 v[220:223], v7, s[52:55], s64 offen offset:3584 nt
    s_waitcnt vmcnt(16)
    v_mfma_f32_16x16x32_bf16 v[40:43], v[32:35], v[128:131], 0
    v_mfma_f32_16x16x32_bf16 v[44:47], v[32:35], v[136:139], 0
    v_mfma_f32_16x16x32_bf16 v[48:51], v[32:35], v[144:147], 0
    v_mfma_f32_16x16x32_bf16 v[52:55], v[32:35], v[152:155], 0
    v_mfma_f32_16x16x32_bf16 v[40:43], v[36:39], v[132:135], v[40:43]
    v_mfma_f32_16x16x32_bf16 v[44:47], v[36:39], v[140:143], v[44:47]
    v_mfma_f32_16x16x32_bf16 v[48:51], v[36:39], v[148:151], v[48:51]
    v_mfma_f32_16x16x32_bf16 v[52:55], v[36:39], v[156:159], v[52:55]
    s_nop 4
    v_mov_b32_dpp v56, v40 quad_perm:[0,0,0,0] row_mask:0xf bank_mask:0xf
    v_mov_b32_dpp v57, v44 quad_perm:[0,0,0,0] row_mask:0xf bank_mask:0xf
    v_mov_b32_dpp v58, v48 quad_perm:[0,0,0,0] row_mask:0xf bank_mask:0xf
    v_mov_b32_dpp v59, v52 quad_perm:[0,0,0,0] row_mask:0xf bank_mask:0xf
    v_add_f32_dpp v56, v41, v56 quad_perm:[1,1,1,1] row_mask:0xf bank_mask:0xf
    v_add_f32_dpp v57, v45, v57 quad_perm:[1,1,1,1] row_mask:0xf bank_mask:0xf
    v_add_f32_dpp v58, v49, v58 quad_perm:[1,1,1,1] row_mask:0xf bank_mask:0xf
    v_add_f32_dpp v59, v53, v59 quad_perm:[1,1,1,1] row_mask:0xf bank_mask:0xf
    v_add_f32_dpp v56, v42, v56 quad_perm:[2,2,2,2] row_mask:0xf bank_mask:0xf
    v_add_f32_dpp v57, v46, v57 quad_perm:[2,2,2,2] row_mask:0xf bank_mask:0xf
    v_add_f32_dpp v58, v50, v58 quad_perm:[2,2,2,2] row_mask:0xf bank_mask:0xf
    v_add_f32_dpp v59, v54, v59 quad_perm:[2,2,2,2] row_mask:0xf bank_mask:0xf
    v_add_f32_dpp v56, v43, v56 quad_perm:[3,3,3,3] row_mask:0xf bank_mask:0xf
    v_add_f32_dpp v57, v47, v57 quad_perm:[3,3,3,3] row_mask:0xf bank_mask:0xf
    v_add_f32_dpp v58, v51, v58 quad_perm:[3,3,3,3] row_mask:0xf bank_mask:0xf
    v_add_f32_dpp v59, v55, v59 quad_perm:[3,3,3,3] row_mask:0xf bank_mask:0xf
    v_cndmask_b32 v56, v56, v57, s[22:23]
    v_cndmask_b32 v56, v56, v58, s[24:25]
    v_cndmask_b32 v56, v56, v59, s[26:27]
    v_mov_b32 v57, v56
    s_nop 1
    v_permlane16_swap_b32 v56, v57
    v_cvt_pk_bf16_f32 v226, v56, v57
    buffer_load_dwordx4 v[64:67], v7, s[52:55], s65 offen offset:0 nt
    s_waitcnt vmcnt(9)
    v_mfma_f32_16x16x32_bf16 v[40:43], v[32:35], v[160:163], 0
    v_mfma_f32_16x16x32_bf16 v[44:47], v[32:35], v[168:171], 0
    v_mfma_f32_16x16x32_bf16 v[48:51], v[32:35], v[176:179], 0
    v_mfma_f32_16x16x32_bf16 v[52:55], v[32:35], v[184:187], 0
    v_mfma_f32_16x16x32_bf16 v[40:43], v[36:39], v[164:167], v[40:43]
    v_mfma_f32_16x16x32_bf16 v[44:47], v[36:39], v[172:175], v[44:47]
    v_mfma_f32_16x16x32_bf16 v[48:51], v[36:39], v[180:183], v[48:51]
    v_mfma_f32_16x16x32_bf16 v[52:55], v[36:39], v[188:191], v[52:55]
    s_nop 4
    v_mov_b32_dpp v56, v40 quad_perm:[0,0,0,0] row_mask:0xf bank_mask:0xf
    v_mov_b32_dpp v57, v44 quad_perm:[0,0,0,0] row_mask:0xf bank_mask:0xf
    v_mov_b32_dpp v58, v48 quad_perm:[0,0,0,0] row_mask:0xf bank_mask:0xf
    v_mov_b32_dpp v59, v52 quad_perm:[0,0,0,0] row_mask:0xf bank_mask:0xf
    v_add_f32_dpp v56, v41, v56 quad_perm:[1,1,1,1] row_mask:0xf bank_mask:0xf
    v_add_f32_dpp v57, v45, v57 quad_perm:[1,1,1,1] row_mask:0xf bank_mask:0xf
    v_add_f32_dpp v58, v49, v58 quad_perm:[1,1,1,1] row_mask:0xf bank_mask:0xf
    v_add_f32_dpp v59, v53, v59 quad_perm:[1,1,1,1] row_mask:0xf bank_mask:0xf
    v_add_f32_dpp v56, v42, v56 quad_perm:[2,2,2,2] row_mask:0xf bank_mask:0xf
    v_add_f32_dpp v57, v46, v57 quad_perm:[2,2,2,2] row_mask:0xf bank_mask:0xf
    v_add_f32_dpp v58, v50, v58 quad_perm:[2,2,2,2] row_mask:0xf bank_mask:0xf
    v_add_f32_dpp v59, v54, v59 quad_perm:[2,2,2,2] row_mask:0xf bank_mask:0xf
    v_add_f32_dpp v56, v43, v56 quad_perm:[3,3,3,3] row_mask:0xf bank_mask:0xf
    v_add_f32_dpp v57, v47, v57 quad_perm:[3,3,3,3] row_mask:0xf bank_mask:0xf
    v_add_f32_dpp v58, v51, v58 quad_perm:[3,3,3,3] row_mask:0xf bank_mask:0xf
    v_add_f32_dpp v59, v55, v59 quad_perm:[3,3,3,3] row_mask:0xf bank_mask:0xf
    v_cndmask_b32 v56, v56, v57, s[22:23]
    v_cndmask_b32 v56, v56, v58, s[24:25]
    v_cndmask_b32 v56, v56, v59, s[26:27]
    v_mov_b32 v57, v56
    s_nop 1
    v_permlane16_swap_b32 v56, v57
    v_cvt_pk_bf16_f32 v227, v56, v57
    v_cndmask_b32 v228, v224, v225, s[16:17]
    v_cndmask_b32 v228, v228, v226, s[18:19]
    v_cndmask_b32 v228, v228, v227, s[20:21]
    buffer_store_dwordx2 v[228:229], v9, s[60:63], s15 offen sc1
    ds_add_u32 v4, v5 offset:8
    buffer_load_dwordx4 v[68:71], v7, s[52:55], s65 offen offset:512 nt
    s_cmp_lg_u32 s47, 0
    s_cbranch_scc1 L_sk_3
    s_waitcnt vmcnt(5)
L_sk_3:
    buffer_load_dwordx4 v[72:75], v7, s[52:55], s65 offen offset:1024 nt
    s_cmp_lg_u32 s47, 0
    s_cbranch_scc1 L_sk_4
    s_waitcnt vmcnt(5)
L_sk_4:
    buffer_load_dwordx4 v[76:79], v7, s[52:55], s65 offen offset:1536 nt
    s_cmp_lg_u32 s47, 0
    s_cbranch_scc1 L_sk_5
    s_waitcnt vmcnt(5)
L_sk_5:
    buffer_load_dwordx4 v[80:83], v7, s[52:55], s65 offen offset:2048 nt
    s_cmp_lg_u32 s47, 0
    s_cbranch_scc1 L_sk_6
    s_waitcnt vmcnt(5)
L_sk_6:
    buffer_load_dwordx4 v[84:87], v7, s[52:55], s65 offen offset:2560 nt
    s_cmp_lg_u32 s47, 0
    s_cbranch_scc1 L_sk_7
    s_waitcnt vmcnt(5)
L_sk_7:
    ds_add_u32 v4, v5 offset:24
    buffer_load_dwordx4 v[88:91], v7, s[52:55], s65 offen offset:3072 nt
    s_cmp_lg_u32 s47, 0
    s_cbranch_scc1 L_sk_8
    s_waitcnt vmcnt(5)
    ds_read_b32 v13, v4 offset:40
    s_waitcnt lgkmcnt(0)
    v_readfirstlane_b32 s46, v13
    s_nop 1
    s_lshr_b32 s47, s46, 6
L_sk_8:
    buffer_load_dwordx4 v[92:95], v7, s[52:55], s65 offen offset:3584 nt
    s_cmp_lg_u32 s47, 0
    s_cbranch_scc1 L_sk_9
    s_waitcnt vmcnt(5)
    ds_read_b32 v13, v4 offset:40
    s_waitcnt lgkmcnt(0)
    v_readfirstlane_b32 s46, v13
    s_nop 1
    s_lshr_b32 s47, s46, 6
L_sk_9:
    buffer_load_dwordx4 v[96:99], v7, s[52:55], s66 offen offset:0 nt
    s_cmp_lg_u32 s47, 0
    s_cbranch_scc1 L_sk_10
    s_waitcnt vmcnt(5)
    ds_read_b32 v13, v4 offset:40
    s_waitcnt lgkmcnt(0)
    v_readfirstlane_b32 s46, v13
    s_nop 1
    s_lshr_b32 s47, s46, 6
L_sk_10:
    buffer_load_dwordx4 v[100:103], v7, s[52:55], s66 offen offset:512 nt
    s_cmp_lg_u32 s47, 0
    s_cbranch_scc1 L_sk_11
    s_waitcnt vmcnt(5)
    ds_read_b32 v13, v4 offset:40
    s_waitcnt lgkmcnt(0)
    v_readfirstlane_b32 s46, v13
    s_nop 1
    s_lshr_b32 s47, s46, 6
L_sk_11:
    buffer_load_dwordx4 v[104:107], v7, s[52:55], s66 offen offset:1024 nt
    s_cmp_lg_u32 s47, 0
    s_cbranch_scc1 L_sk_12
    s_waitcnt vmcnt(5)
    ds_read_b32 v13, v4 offset:40
    s_waitcnt lgkmcnt(0)
    v_readfirstlane_b32 s46, v13
    s_nop 1
    s_lshr_b32 s47, s46, 6
L_sk_12:
    buffer_load_dwordx4 v[108:111], v7, s[52:55], s66 offen offset:1536 nt
    s_cmp_lg_u32 s47, 0
    s_cbranch_scc1 L_sk_13
    s_waitcnt vmcnt(5)
    ds_read_b32 v13, v4 offset:40
    s_waitcnt lgkmcnt(0)
    v_readfirstlane_b32 s46, v13
    s_nop 1
    s_lshr_b32 s47, s46, 6
L_sk_13:
    buffer_load_dwordx4 v[112:115], v7, s[52:55], s66 offen offset:2048 nt
    s_cmp_lg_u32 s47, 0
    s_cbranch_scc1 L_sk_14
    s_waitcnt vmcnt(5)
    ds_read_b32 v13, v4 offset:40
    s_waitcnt lgkmcnt(0)
    v_readfirstlane_b32 s46, v13
    s_nop 1
    s_lshr_b32 s47, s46, 6
L_sk_14:
    buffer_load_dwordx4 v[116:119], v7, s[52:55], s66 offen offset:2560 nt
    s_cmp_lg_u32 s47, 0
    s_cbranch_scc1 L_sk_15
    s_waitcnt vmcnt(5)
    ds_read_b32 v13, v4 offset:40
    s_waitcnt lgkmcnt(0)
    v_readfirstlane_b32 s46, v13
    s_nop 1
    s_lshr_b32 s47, s46, 6
L_sk_15:
    buffer_load_dwordx4 v[120:123], v7, s[52:55], s66 offen offset:3072 nt
    s_cmp_lg_u32 s47, 0
    s_cbranch_scc1 L_sk_16
    s_waitcnt vmcnt(5)
    ds_read_b32 v13, v4 offset:40
    s_waitcnt lgkmcnt(0)
    v_readfirstlane_b32 s46, v13
    s_nop 1
    s_lshr_b32 s47, s46, 6
L_sk_16:
    buffer_load_dwordx4 v[124:127], v7, s[52:55], s66 offen offset:3584 nt
    s_cmp_lg_u32 s47, 0
    s_cbranch_scc1 L_sk_17
    s_waitcnt vmcnt(5)
    ds_read_b32 v13, v4 offset:40
    s_waitcnt lgkmcnt(0)
    v_readfirstlane_b32 s46, v13
    s_nop 1
    s_lshr_b32 s47, s46, 6
L_sk_17:
    buffer_load_dwordx4 v[128:131], v7, s[52:55], s67 offen offset:0 nt
    s_cmp_lg_u32 s47, 0
    s_cbranch_scc1 L_sk_18
    s_waitcnt vmcnt(5)
    ds_read_b32 v13, v4 offset:40
    s_waitcnt lgkmcnt(0)
    v_readfirstlane_b32 s46, v13
    s_nop 1
    s_lshr_b32 s47, s46, 6
L_sk_18:
    buffer_load_dwordx4 v[132:135], v7, s[52:55], s67 offen offset:512 nt
    s_cmp_lg_u32 s47, 0
    s_cbranch_scc1 L_sk_19
    s_waitcnt vmcnt(5)
    ds_read_b32 v13, v4 offset:40
    s_waitcnt lgkmcnt(0)
    v_readfirstlane_b32 s46, v13
    s_nop 1
    s_lshr_b32 s47, s46, 6
L_sk_19:
    buffer_load_dwordx4 v[136:139], v7, s[52:55], s67 offen offset:1024 nt
    s_cmp_lg_u32 s47, 0
    s_cbranch_scc1 L_sk_20
    s_waitcnt vmcnt(5)
    ds_read_b32 v13, v4 offset:40
    s_waitcnt lgkmcnt(0)
    v_readfirstlane_b32 s46, v13
    s_nop 1
    s_lshr_b32 s47, s46, 6
L_sk_20:
    buffer_load_dwordx4 v[140:143], v7, s[52:55], s67 offen offset:1536 nt
    s_cmp_lg_u32 s47, 0
    s_cbranch_scc1 L_sk_21
    s_waitcnt vmcnt(5)
    ds_read_b32 v13, v4 offset:40
    s_waitcnt lgkmcnt(0)
    v_readfirstlane_b32 s46, v13
    s_nop 1
    s_lshr_b32 s47, s46, 6
L_sk_21:
    buffer_load_dwordx4 v[144:147], v7, s[52:55], s67 offen offset:2048 nt
    s_cmp_lg_u32 s47, 0
    s_cbranch_scc1 L_sk_22
    s_waitcnt vmcnt(5)
    ds_read_b32 v13, v4 offset:40
    s_waitcnt lgkmcnt(0)
    v_readfirstlane_b32 s46, v13
    s_nop 1
    s_lshr_b32 s47, s46, 6
L_sk_22:
    buffer_load_dwordx4 v[148:151], v7, s[52:55], s67 offen offset:2560 nt
    s_cmp_lg_u32 s47, 0
    s_cbranch_scc1 L_sk_23
    s_waitcnt vmcnt(5)
    ds_read_b32 v13, v4 offset:40
    s_waitcnt lgkmcnt(0)
    v_readfirstlane_b32 s46, v13
    s_nop 1
    s_lshr_b32 s47, s46, 6
L_sk_23:
    buffer_load_dwordx4 v[152:155], v7, s[52:55], s67 offen offset:3072 nt
    s_cmp_lg_u32 s47, 0
    s_cbranch_scc1 L_sk_24
    s_waitcnt vmcnt(5)
    ds_read_b32 v13, v4 offset:40
    s_waitcnt lgkmcnt(0)
    v_readfirstlane_b32 s46, v13
    s_nop 1
    s_lshr_b32 s47, s46, 6
L_sk_24:
    buffer_load_dwordx4 v[156:159], v7, s[52:55], s67 offen offset:3584 nt
    ds_add_u32 v4, v5 offset:36
    s_waitcnt vmcnt(25)
    v_perm_b32 v160, v196, v192, s68
    v_perm_b32 v161, v204, v200, s68
    v_perm_b32 v162, v212, v208, s68
    v_perm_b32 v163, v220, v216, s68
    v_perm_b32 v164, v196, v192, s69
    v_perm_b32 v165, v204, v200, s69
    v_perm_b32 v166, v212, v208, s69
    v_perm_b32 v167, v220, v216, s69
    v_perm_b32 v168, v197, v193, s68
    v_perm_b32 v169, v205, v201, s68
    v_perm_b32 v170, v213, v209, s68
    v_perm_b32 v171, v221, v217, s68
    v_perm_b32 v172, v197, v193, s69
    v_perm_b32 v173, v205, v201, s69
    v_perm_b32 v174, v213, v209, s69
    v_perm_b32 v175, v221, v217, s69
    v_perm_b32 v176, v198, v194, s68
    v_perm_b32 v177, v206, v202, s68
    v_perm_b32 v178, v214, v210, s68
    v_perm_b32 v179, v222, v218, s68
    v_perm_b32 v180, v198, v194, s69
    v_perm_b32 v181, v206, v202, s69
    v_perm_b32 v182, v214, v210, s69
    v_perm_b32 v183, v222, v218, s69
    v_perm_b32 v184, v199, v195, s68
    v_perm_b32 v185, v207, v203, s68
    v_perm_b32 v186, v215, v211, s68
    v_perm_b32 v187, v223, v219, s68
    v_perm_b32 v188, v199, v195, s69
    v_perm_b32 v189, v207, v203, s69
    v_perm_b32 v190, v215, v211, s69
    v_perm_b32 v191, v223, v219, s69
    s_waitcnt vmcnt(16)
    v_perm_b32 v192, v68, v64, s68
    v_perm_b32 v193, v76, v72, s68
    v_perm_b32 v194, v84, v80, s68
    v_perm_b32 v195, v92, v88, s68
    v_perm_b32 v196, v68, v64, s69
    v_perm_b32 v197, v76, v72, s69
    v_perm_b32 v198, v84, v80, s69
    v_perm_b32 v199, v92, v88, s69
    v_perm_b32 v200, v69, v65, s68
    v_perm_b32 v201, v77, v73, s68
    v_perm_b32 v202, v85, v81, s68
    v_perm_b32 v203, v93, v89, s68
    v_perm_b32 v204, v69, v65, s69
    v_perm_b32 v205, v77, v73, s69
    v_perm_b32 v206, v85, v81, s69
    v_perm_b32 v207, v93, v89, s69
    v_perm_b32 v208, v70, v66, s68
    v_perm_b32 v209, v78, v74, s68
    v_perm_b32 v210, v86, v82, s68
    v_perm_b32 v211, v94, v90, s68
    v_perm_b32 v212, v70, v66, s69
    v_perm_b32 v213, v78, v74, s69
    v_perm_b32 v214, v86, v82, s69
    v_perm_b32 v215, v94, v90, s69
    v_perm_b32 v216, v71, v67, s68
    v_perm_b32 v217, v79, v75, s68
    v_perm_b32 v218, v87, v83, s68
    v_perm_b32 v219, v95, v91, s68
    v_perm_b32 v220, v71, v67, s69
    v_perm_b32 v221, v79, v75, s69
    v_perm_b32 v222, v87, v83, s69
    v_perm_b32 v223, v95, v91, s69
    s_waitcnt vmcnt(8)
    v_perm_b32 v64, v100, v96, s68
    v_perm_b32 v65, v108, v104, s68
    v_perm_b32 v66, v116, v112, s68
    v_perm_b32 v67, v124, v120, s68
    v_perm_b32 v68, v100, v96, s69
    v_perm_b32 v69, v108, v104, s69
    v_perm_b32 v70, v116, v112, s69
    v_perm_b32 v71, v124, v120, s69
    v_perm_b32 v72, v101, v97, s68
    v_perm_b32 v73, v109, v105, s68
    v_perm_b32 v74, v117, v113, s68
    v_perm_b32 v75, v125, v121, s68
    v_perm_b32 v76, v101, v97, s69
    v_perm_b32 v77, v109, v105, s69
    v_perm_b32 v78, v117, v113, s69
    v_perm_b32 v79, v125, v121, s69
    v_perm_b32 v80, v102, v98, s68
    v_perm_b32 v81, v110, v106, s68
    v_perm_b32 v82, v118, v114, s68
    v_perm_b32 v83, v126, v122, s68
    v_perm_b32 v84, v102, v98, s69
    v_perm_b32 v85, v110, v106, s69
    v_perm_b32 v86, v118, v114, s69
    v_perm_b32 v87, v126, v122, s69
    v_perm_b32 v88, v103, v99, s68
    v_perm_b32 v89, v111, v107, s68
    v_perm_b32 v90, v119, v115, s68
    v_perm_b32 v91, v127, v123, s68
    v_perm_b32 v92, v103, v99, s69
    v_perm_b32 v93, v111, v107, s69
    v_perm_b32 v94, v119, v115, s69
    v_perm_b32 v95, v127, v123, s69
    ds_read_b32 v13, v4 offset:12
    s_waitcnt lgkmcnt(0)
    v_readfirstlane_b32 s46, v13
    s_nop 1
    s_lshr_b32 s47, s46, 7
    s_cmp_lg_u32 s47, 0
    s_cbranch_scc1 L_p_early
    s_waitcnt vmcnt(0)
    v_perm_b32 v96, v132, v128, s68
    v_perm_b32 v97, v140, v136, s68
    v_perm_b32 v98, v148, v144, s68
    v_perm_b32 v99, v156, v152, s68
    v_perm_b32 v100, v132, v128, s69
    v_perm_b32 v101, v140, v136, s69
    v_perm_b32 v102, v148, v144, s69
    v_perm_b32 v103, v156, v152, s69
    v_perm_b32 v104, v133, v129, s68
    v_perm_b32 v105, v141, v137, s68
    v_perm_b32 v106, v149, v145, s68
    v_perm_b32 v107, v157, v153, s68
    v_perm_b32 v108, v133, v129, s69
    v_perm_b32 v109, v141, v137, s69
    v_perm_b32 v110, v149, v145, s69
    v_perm_b32 v111, v157, v153, s69
    v_perm_b32 v112, v134, v130, s68
    v_perm_b32 v113, v142, v138, s68
    v_perm_b32 v114, v150, v146, s68
    v_perm_b32 v115, v158, v154, s68
    v_perm_b32 v116, v134, v130, s69
    v_perm_b32 v117, v142, v138, s69
    v_perm_b32 v118, v150, v146, s69
    v_perm_b32 v119, v158, v154, s69
    v_perm_b32 v120, v135, v131, s68
    v_perm_b32 v121, v143, v139, s68
    v_perm_b32 v122, v151, v147, s68
    v_perm_b32 v123, v159, v155, s68
    v_perm_b32 v124, v135, v131, s69
    v_perm_b32 v125, v143, v139, s69
    v_perm_b32 v126, v151, v147, s69
    v_perm_b32 v127, v159, v155, s69
    s_mov_b32 s45, 0x100000
L_fl_25:
    ds_read_b32 v13, v4 offset:12
    s_waitcnt lgkmcnt(0)
    v_readfirstlane_b32 s46, v13
    s_nop 1
    s_cmp_ge_u32 s46, 128
    s_cbranch_scc1 L_fld_26
    s_sub_u32 s45, s45, 1
    s_cmp_lg_u32 s45, 0
    s_cbranch_scc1 L_fl_25
L_fld_26:
L_p_early:
    ds_read_b128 v[16:19], v11 offset:0
    ds_read_b128 v[20:23], v11 offset:512
    ds_read_b128 v[24:27], v11 offset:1024
    ds_read_b128 v[28:31], v11 offset:1536
    s_waitcnt lgkmcnt(3)
    v_mfma_f32_16x16x32_bf16 v[32:35], v[16:19], v[160:163], 0
    v_mfma_f32_16x16x32_bf16 v[36:39], v[16:19], v[164:167], 0
    v_mfma_f32_16x16x32_bf16 v[40:43], v[16:19], v[168:171], 0
    v_mfma_f32_16x16x32_bf16 v[44:47], v[16:19], v[172:175], 0
    v_mfma_f32_16x16x32_bf16 v[48:51], v[16:19], v[176:179], 0
    v_mfma_f32_16x16x32_bf16 v[52:55], v[16:19], v[180:183], 0
    v_mfma_f32_16x16x32_bf16 v[56:59], v[16:19], v[184:187], 0
    v_mfma_f32_16x16x32_bf16 v[60:63], v[16:19], v[188:191], 0
    s_waitcnt lgkmcnt(2)
    v_mfma_f32_16x16x32_bf16 v[32:35], v[20:23], v[192:195], v[32:35]
    v_mfma_f32_16x16x32_bf16 v[36:39], v[20:23], v[196:199], v[36:39]
    v_mfma_f32_16x16x32_bf16 v[40:43], v[20:23], v[200:203], v[40:43]
    v_mfma_f32_16x16x32_bf16 v[44:47], v[20:23], v[204:207], v[44:47]
    v_mfma_f32_16x16x32_bf16 v[48:51], v[20:23], v[208:211], v[48:51]
    v_mfma_f32_16x16x32_bf16 v[52:55], v[20:23], v[212:215], v[52:55]
    v_mfma_f32_16x16x32_bf16 v[56:59], v[20:23], v[216:219], v[56:59]
    v_mfma_f32_16x16x32_bf16 v[60:63], v[20:23], v[220:223], v[60:63]
    s_waitcnt lgkmcnt(1)
    v_mfma_f32_16x16x32_bf16 v[32:35], v[24:27], v[64:67], v[32:35]
    v_mfma_f32_16x16x32_bf16 v[36:39], v[24:27], v[68:71], v[36:39]
    v_mfma_f32_16x16x32_bf16 v[40:43], v[24:27], v[72:75], v[40:43]
    v_mfma_f32_16x16x32_bf16 v[44:47], v[24:27], v[76:79], v[44:47]
    v_mfma_f32_16x16x32_bf16 v[48:51], v[24:27], v[80:83], v[48:51]
    v_mfma_f32_16x16x32_bf16 v[52:55], v[24:27], v[84:87], v[52:55]
    v_mfma_f32_16x16x32_bf16 v[56:59], v[24:27], v[88:91], v[56:59]
    v_mfma_f32_16x16x32_bf16 v[60:63], v[24:27], v[92:95], v[60:63]
    s_cmp_lg_u32 s47, 0
    s_cbranch_scc0 L_p_late
    s_waitcnt vmcnt(0)
    v_perm_b32 v96, v132, v128, s68
    v_perm_b32 v97, v140, v136, s68
    v_perm_b32 v98, v148, v144, s68
    v_perm_b32 v99, v156, v152, s68
    v_perm_b32 v100, v132, v128, s69
    v_perm_b32 v101, v140, v136, s69
    v_perm_b32 v102, v148, v144, s69
    v_perm_b32 v103, v156, v152, s69
    v_perm_b32 v104, v133, v129, s68
    v_perm_b32 v105, v141, v137, s68
    v_perm_b32 v106, v149, v145, s68
    v_perm_b32 v107, v157, v153, s68
    v_perm_b32 v108, v133, v129, s69
    v_perm_b32 v109, v141, v137, s69
    v_perm_b32 v110, v149, v145, s69
    v_perm_b32 v111, v157, v153, s69
    v_perm_b32 v112, v134, v130, s68
    v_perm_b32 v113, v142, v138, s68
    v_perm_b32 v114, v150, v146, s68
    v_perm_b32 v115, v158, v154, s68
    v_perm_b32 v116, v134, v130, s69
    v_perm_b32 v117, v142, v138, s69
    v_perm_b32 v118, v150, v146, s69
    v_perm_b32 v119, v158, v154, s69
    v_perm_b32 v120, v135, v131, s68
    v_perm_b32 v121, v143, v139, s68
    v_perm_b32 v122, v151, v147, s68
    v_perm_b32 v123, v159, v155, s68
    v_perm_b32 v124, v135, v131, s69
    v_perm_b32 v125, v143, v139, s69
    v_perm_b32 v126, v151, v147, s69
    v_perm_b32 v127, v159, v155, s69
L_p_late:
    s_waitcnt lgkmcnt(0)
    v_mfma_f32_16x16x32_bf16 v[32:35], v[28:31], v[96:99], v[32:35]
    v_mfma_f32_16x16x32_bf16 v[36:39], v[28:31], v[100:103], v[36:39]
    v_mfma_f32_16x16x32_bf16 v[40:43], v[28:31], v[104:107], v[40:43]
    v_mfma_f32_16x16x32_bf16 v[44:47], v[28:31], v[108:111], v[44:47]
    v_mfma_f32_16x16x32_bf16 v[48:51], v[28:31], v[112:115], v[48:51]
    v_mfma_f32_16x16x32_bf16 v[52:55], v[28:31], v[116:119], v[52:55]
    v_mfma_f32_16x16x32_bf16 v[56:59], v[28:31], v[120:123], v[56:59]
    v_mfma_f32_16x16x32_bf16 v[60:63], v[28:31], v[124:127], v[60:63]
    s_nop 0
    v_add_f32_dpp v64, v33, v32 row_ror:8 row_mask:0xf bank_mask:0xf
    v_add_f32_dpp v65, v37, v36 row_ror:8 row_mask:0xf bank_mask:0xf
    v_add_f32_dpp v66, v41, v40 row_ror:8 row_mask:0xf bank_mask:0xf
    v_add_f32_dpp v67, v45, v44 row_ror:8 row_mask:0xf bank_mask:0xf
    v_add_f32_dpp v68, v49, v48 row_ror:8 row_mask:0xf bank_mask:0xf
    v_add_f32_dpp v69, v53, v52 row_ror:8 row_mask:0xf bank_mask:0xf
    v_add_f32_dpp v70, v57, v56 row_ror:8 row_mask:0xf bank_mask:0xf
    v_add_f32_dpp v71, v61, v60 row_ror:8 row_mask:0xf bank_mask:0xf
    v_add_f32_dpp v72, v35, v34 row_ror:8 row_mask:0xf bank_mask:0xf
    v_add_f32_dpp v73, v39, v38 row_ror:8 row_mask:0xf bank_mask:0xf
    v_add_f32_dpp v74, v43, v42 row_ror:8 row_mask:0xf bank_mask:0xf
    v_add_f32_dpp v75, v47, v46 row_ror:8 row_mask:0xf bank_mask:0xf
    v_add_f32_dpp v76, v51, v50 row_ror:8 row_mask:0xf bank_mask:0xf
    v_add_f32_dpp v77, v55, v54 row_ror:8 row_mask:0xf bank_mask:0xf
    v_add_f32_dpp v78, v59, v58 row_ror:8 row_mask:0xf bank_mask:0xf
    v_add_f32_dpp v79, v63, v62 row_ror:8 row_mask:0xf bank_mask:0xf
    s_mov_b64 exec, 0xff
    ds_write_b128 v12, v[64:67] offset:0
    ds_write_b128 v12, v[68:71] offset:16
    ds_write_b128 v12, v[72:75] offset:256
    ds_write_b128 v12, v[76:79] offset:272
    s_mov_b64 exec, -1
    s_waitcnt lgkmcnt(0)
    s_barrier
    s_endpgm
L_s0_main:
    v_mov_b32 v13, 2147418112
    s_mov_b32 s45, 0x100000
L_fl_28:
    ds_read_b32 v26, v4 offset:28
    s_waitcnt lgkmcnt(0)
    v_readfirstlane_b32 s46, v26
    s_nop 1
    s_cmp_ge_u32 s46, 1
    s_cbranch_scc1 L_fld_29
    s_sub_u32 s45, s45, 1
    s_cmp_lg_u32 s45, 0
    s_cbranch_scc1 L_fl_28
L_fld_29:
    v_and_b32 v12, 7, v2
    v_mul_u32_u24 v12, 896, v12
    v_lshl_add_u32 v12, v3, 4, v12
    v_add_u32 v12, 52224, v12
    ds_read_b128 v[64:67], v12 offset:0
    ds_read_b128 v[68:71], v12 offset:64
    ds_read_b128 v[72:75], v12 offset:128
    ds_read_b128 v[76:79], v12 offset:192
    ds_read_b128 v[80:83], v12 offset:256
    ds_read_b128 v[84:87], v12 offset:320
    ds_read_b128 v[88:91], v12 offset:384
    ds_read_b128 v[92:95], v12 offset:448
    ds_read_b128 v[96:99], v12 offset:512
    ds_read_b128 v[100:103], v12 offset:576
    ds_read_b128 v[104:107], v12 offset:640
    ds_read_b128 v[108:111], v12 offset:704
    ds_read_b128 v[112:115], v12 offset:768
    ds_read_b128 v[116:119], v12 offset:832
    s_mul_i32 s10, s4, 896
    s_add_u32 s10, s10, 52224
    v_min_u32 v14, 55, v0
    v_lshlrev_b32 v14, 4, v14
    v_add_u32 v14, s10, v14
    ds_read_b128 v[32:35], v14
    s_waitcnt vmcnt(0) lgkmcnt(0)
    s_mov_b32 s52, s36
    s_mov_b32 s53, s37
    s_mov_b32 s54, 896
    s_mov_b32 s55, 0x20000
    v_lshlrev_b32 v14, 4, v0
    v_cmp_gt_u32 vcc, 56, v0
    s_nop 1
    v_cndmask_b32 v14, v13, v14, vcc
    buffer_load_dwordx4 v[36:39], v14, s[52:55], 0 offen
    s_mov_b32 s56, s34
    s_mov_b32 s57, s35
    s_mov_b32 s58, 896
    s_mov_b32 s59, 0x20000
    v_and_b32 v15, 7, v0
    v_lshlrev_b32 v15, 2, v15
    s_lshl_b32 s10, s7, 5
    buffer_load_dword v52, v15, s[56:59], s10 offen
    s_mul_i32 s44, s44, 1664525
    s_add_u32 s44, s44, 1013904223
    s_bitcmp1_b32 s9, 0
    s_cbranch_scc1 L_s0_noq2
    v_lshrrev_b32 v15, 2, v2
    v_lshl_add_u32 v15, v3, 3, v15
    v_lshlrev_b32 v15, 6, v15
    v_add_u32 v15, v15, v7
    v_add_u32 v15, 16384, v15
    ds_read_b64_tr_b16 v[128:129], v15 offset:0
    ds_read_b64_tr_b16 v[130:131], v15 offset:256
    ds_read_b64_tr_b16 v[132:133], v15 offset:32
    ds_read_b64_tr_b16 v[134:135], v15 offset:288
    ds_read_b64_tr_b16 v[136:137], v15 offset:2048
    ds_read_b64_tr_b16 v[138:139], v15 offset:2304
    ds_read_b64_tr_b16 v[140:141], v15 offset:2080
    ds_read_b64_tr_b16 v[142:143], v15 offset:2336
    ds_read_b64_tr_b16 v[144:145], v15 offset:4096
    ds_read_b64_tr_b16 v[146:147], v15 offset:4352
    ds_read_b64_tr_b16 v[148:149], v15 offset:4128
    ds_read_b64_tr_b16 v[150:151], v15 offset:4384
    ds_read_b64_tr_b16 v[152:153], v15 offset:6144
    ds_read_b64_tr_b16 v[154:155], v15 offset:6400
    ds_read_b64_tr_b16 v[156:157], v15 offset:6176
    ds_read_b64_tr_b16 v[158:159], v15 offset:6432
    ds_read_b64_tr_b16 v[160:161], v15 offset:8192
    ds_read_b64_tr_b16 v[162:163], v15 offset:8448
    ds_read_b64_tr_b16 v[164:165], v15 offset:8224
    ds_read_b64_tr_b16 v[166:167], v15 offset:8480
    ds_read_b64_tr_b16 v[168:169], v15 offset:10240
    ds_read_b64_tr_b16 v[170:171], v15 offset:10496
    ds_read_b64_tr_b16 v[172:173], v15 offset:10272
    ds_read_b64_tr_b16 v[174:175], v15 offset:10528
    ds_read_b64_tr_b16 v[176:177], v15 offset:12288
    ds_read_b64_tr_b16 v[178:179], v15 offset:12544
    ds_read_b64_tr_b16 v[180:181], v15 offset:12320
    ds_read_b64_tr_b16 v[182:183], v15 offset:12576
    ds_read_b64_tr_b16 v[184:185], v15 offset:14336
    ds_read_b64_tr_b16 v[186:187], v15 offset:14592
    ds_read_b64_tr_b16 v[188:189], v15 offset:14368
    ds_read_b64_tr_b16 v[190:191], v15 offset:14624
    ds_read_b64_tr_b16 v[192:193], v15 offset:16384
    ds_read_b64_tr_b16 v[194:195], v15 offset:16640
    ds_read_b64_tr_b16 v[196:197], v15 offset:16416
    ds_read_b64_tr_b16 v[198:199], v15 offset:16672
    ds_read_b64_tr_b16 v[200:201], v15 offset:18432
    ds_read_b64_tr_b16 v[202:203], v15 offset:18688
    ds_read_b64_tr_b16 v[204:205], v15 offset:18464
    ds_read_b64_tr_b16 v[206:207], v15 offset:18720
    ds_read_b64_tr_b16 v[208:209], v15 offset:20480
    ds_read_b64_tr_b16 v[210:211], v15 offset:20736
    ds_read_b64_tr_b16 v[212:213], v15 offset:20512
    ds_read_b64_tr_b16 v[214:215], v15 offset:20768
    ds_read_b64_tr_b16 v[216:217], v15 offset:22528
    ds_read_b64_tr_b16 v[218:219], v15 offset:22784
    ds_read_b64_tr_b16 v[220:221], v15 offset:22560
    ds_read_b64_tr_b16 v[222:223], v15 offset:22816
    ds_read_b64_tr_b16 v[224:225], v15 offset:24576
    ds_read_b64_tr_b16 v[226:227], v15 offset:24832
    ds_read_b64_tr_b16 v[228:229], v15 offset:24608
    ds_read_b64_tr_b16 v[230:231], v15 offset:24864
    ds_read_b64_tr_b16 v[232:233], v15 offset:26624
    ds_read_b64_tr_b16 v[234:235], v15 offset:26880
    ds_read_b64_tr_b16 v[236:237], v15 offset:26656
    ds_read_b64_tr_b16 v[238:239], v15 offset:26912
    s_waitcnt lgkmcnt(0)
    v_mfma_f32_16x16x32_bf16 v[16:19], v[128:131], v[64:67], 0
    v_mfma_f32_16x16x32_bf16 v[20:23], v[132:135], v[64:67], 0
    v_mfma_f32_16x16x32_bf16 v[16:19], v[136:139], v[68:71], v[16:19]
    v_mfma_f32_16x16x32_bf16 v[20:23], v[140:143], v[68:71], v[20:23]
    v_mfma_f32_16x16x32_bf16 v[16:19], v[144:147], v[72:75], v[16:19]
    v_mfma_f32_16x16x32_bf16 v[20:23], v[148:151], v[72:75], v[20:23]
    v_mfma_f32_16x16x32_bf16 v[16:19], v[152:155], v[76:79], v[16:19]
    v_mfma_f32_16x16x32_bf16 v[20:23], v[156:159], v[76:79], v[20:23]
    v_mfma_f32_16x16x32_bf16 v[16:19], v[160:163], v[80:83], v[16:19]
    v_mfma_f32_16x16x32_bf16 v[20:23], v[164:167], v[80:83], v[20:23]
    v_mfma_f32_16x16x32_bf16 v[16:19], v[168:171], v[84:87], v[16:19]
    v_mfma_f32_16x16x32_bf16 v[20:23], v[172:175], v[84:87], v[20:23]
    v_mfma_f32_16x16x32_bf16 v[16:19], v[176:179], v[88:91], v[16:19]
    v_mfma_f32_16x16x32_bf16 v[20:23], v[180:183], v[88:91], v[20:23]
    v_mfma_f32_16x16x32_bf16 v[16:19], v[184:187], v[92:95], v[16:19]
    v_mfma_f32_16x16x32_bf16 v[20:23], v[188:191], v[92:95], v[20:23]
    v_mfma_f32_16x16x32_bf16 v[16:19], v[192:195], v[96:99], v[16:19]
    v_mfma_f32_16x16x32_bf16 v[20:23], v[196:199], v[96:99], v[20:23]
    v_mfma_f32_16x16x32_bf16 v[16:19], v[200:203], v[100:103], v[16:19]
    v_mfma_f32_16x16x32_bf16 v[20:23], v[204:207], v[100:103], v[20:23]
    v_mfma_f32_16x16x32_bf16 v[16:19], v[208:211], v[104:107], v[16:19]
    v_mfma_f32_16x16x32_bf16 v[20:23], v[212:215], v[104:107], v[20:23]
    v_mfma_f32_16x16x32_bf16 v[16:19], v[216:219], v[108:111], v[16:19]
    v_mfma_f32_16x16x32_bf16 v[20:23], v[220:223], v[108:111], v[20:23]
    v_mfma_f32_16x16x32_bf16 v[16:19], v[224:227], v[112:115], v[16:19]
    v_mfma_f32_16x16x32_bf16 v[20:23], v[228:231], v[112:115], v[20:23]
    v_mfma_f32_16x16x32_bf16 v[16:19], v[232:235], v[116:119], v[16:19]
    v_mfma_f32_16x16x32_bf16 v[20:23], v[236:239], v[116:119], v[20:23]
    v_lshlrev_b32 v14, 6, v2
    v_lshl_add_u32 v14, v3, 3, v14
    v_add_u32 v14, 76032, v14
    s_nop 3
    v_cvt_pk_bf16_f32 v56, v16, v17
    v_cvt_pk_bf16_f32 v57, v18, v19
    v_cvt_pk_bf16_f32 v58, v20, v21
    v_cvt_pk_bf16_f32 v59, v22, v23
    ds_write_b64 v14, v[56:57]
    ds_write_b64 v14, v[58:59] offset:32
    v_lshlrev_b32 v14, 3, v0
    v_add_u32 v14, 76032, v14
    ds_read_b64 v[60:61], v14
    v_lshrrev_b32 v14, 3, v0
    v_lshlrev_b32 v14, 11, v14
    v_and_b32 v15, 7, v0
    v_lshl_add_u32 v14, v15, 4, v14
    s_lshr_b32 s11, s9, 1
    s_and_b32 s46, s11, 6
    s_cmp_eq_u32 s46, 6
    s_cselect_b32 s46, 8, 0
    s_xor_b32 s11, s11, s46
    s_lshl_b32 s10, s8, 14
    s_lshl_b32 s11, s11, 7
    s_add_u32 s10, s10, s11
    s_add_u32 s10, s10, 4096
    v_mov_b32 v57, s44
    v_mov_b32 v59, s44
    s_waitcnt lgkmcnt(0)
    v_mov_b32 v56, v60
    v_mov_b32 v58, v61
    buffer_store_dwordx4 v[56:59], v14, s[60:63], s10 offen sc1
    s_add_u32 s11, s10, 4194304
L_s0_noq2:
    s_waitcnt vmcnt(0)
    v_lshlrev_b32 v24, 16, v32
    v_and_b32 v25, 0xffff0000, v32
    v_lshlrev_b32 v40, 16, v36
    v_and_b32 v41, 0xffff0000, v36
    v_lshlrev_b32 v26, 16, v33
    v_and_b32 v27, 0xffff0000, v33
    v_lshlrev_b32 v42, 16, v37
    v_and_b32 v43, 0xffff0000, v37
    v_lshlrev_b32 v28, 16, v34
    v_and_b32 v29, 0xffff0000, v34
    v_lshlrev_b32 v44, 16, v38
    v_and_b32 v45, 0xffff0000, v38
    v_lshlrev_b32 v30, 16, v35
    v_and_b32 v31, 0xffff0000, v35
    v_lshlrev_b32 v46, 16, v39
    v_and_b32 v47, 0xffff0000, v39
    v_mul_f32 v24, v24, v40
    v_mul_f32 v25, v25, v41
    v_mul_f32 v26, v26, v42
    v_mul_f32 v27, v27, v43
    v_mul_f32 v28, v28, v44
    v_mul_f32 v29, v29, v45
    v_mul_f32 v30, v30, v46
    v_mul_f32 v31, v31, v47
    v_cvt_pk_bf16_f32 v32, v24, v25
    v_lshlrev_b32 v24, 16, v32
    v_and_b32 v25, 0xffff0000, v32
    v_cvt_pk_bf16_f32 v32, v26, v27
    v_lshlrev_b32 v26, 16, v32
    v_and_b32 v27, 0xffff0000, v32
    v_cvt_pk_bf16_f32 v32, v28, v29
    v_lshlrev_b32 v28, 16, v32
    v_and_b32 v29, 0xffff0000, v32
    v_cvt_pk_bf16_f32 v32, v30, v31
    v_lshlrev_b32 v30, 16, v32
    v_and_b32 v31, 0xffff0000, v32
    v_add_f32 v24, v24, v25
    v_add_f32 v26, v26, v27
    v_add_f32 v28, v28, v29
    v_add_f32 v30, v30, v31
    v_add_f32 v24, v24, v26
    v_add_f32 v28, v28, v30
    v_add_f32 v24, v24, v28
    s_nop 1
    v_add_f32_dpp v24, v24, v24 quad_perm:[1,0,3,2] row_mask:0xf bank_mask:0xf
    s_nop 1
    v_add_f32_dpp v24, v24, v24 quad_perm:[2,3,0,1] row_mask:0xf bank_mask:0xf
    s_nop 1
    v_add_f32_dpp v24, v24, v24 row_half_mirror row_mask:0xf bank_mask:0xf
    s_nop 1
    v_add_f32_dpp v24, v24, v24 row_mirror row_mask:0xf bank_mask:0xf
    v_mov_b32 v25, v24
    s_nop 1
    v_permlane16_swap_b32 v24, v25
    v_add_f32 v24, v24, v25
    v_mov_b32 v25, v24
    s_nop 1
    v_permlane32_swap_b32 v24, v25
    v_add_f32 v24, v24, v25
    v_cvt_pk_bf16_f32 v26, v24, v24
    v_lshlrev_b32 v24, 16, v26
    v_and_b32 v25, 0xffff0000, v26
    v_mul_f32 v24, 0xbfb8aa3b, v24
    v_exp_f32 v24, v24
    s_nop 0
    v_add_f32 v24, 1.0, v24
    v_rcp_f32 v24, v24
    s_nop 0
    v_cvt_pk_bf16_f32 v26, v24, v24
    v_lshlrev_b32 v50, 16, v26
    v_and_b32 v25, 0xffff0000, v26
    v_sub_f32 v24, 1.0, v50
    v_cvt_pk_bf16_f32 v26, v24, v24
    v_lshlrev_b32 v51, 16, v26
    v_and_b32 v25, 0xffff0000, v26
    s_mov_b32 s45, 0x100000
L_fl_30:
    ds_read_b32 v26, v4 offset:20
    s_waitcnt lgkmcnt(0)
    v_readfirstlane_b32 s46, v26
    s_nop 1
    s_cmp_ge_u32 s46, 256
    s_cbranch_scc1 L_fld_31
    s_sub_u32 s45, s45, 1
    s_cmp_lg_u32 s45, 0
    s_cbranch_scc1 L_fl_30
L_fld_31:
    s_lshl_b32 s10, s5, 3
    s_add_u32 s10, s10, s4
    s_lshl_b32 s10, s10, 11
    s_add_u32 s10, s10, 4096
    v_lshlrev_b32 v14, 4, v0
    s_mov_b32 s45, 20000
L_pl_32:
    buffer_load_dwordx4 v[16:19], v14, s[60:63], s10 offen sc1
    buffer_load_dwordx4 v[20:23], v14, s[60:63], s10 offen offset:1024 sc1
    s_waitcnt vmcnt(0)
    v_min_u32 v26, v17, v19
    v_max_u32 v27, v17, v19
    v_min3_u32 v26, v26, v21, v23
    v_max3_u32 v27, v27, v21, v23
    v_cmp_ne_u32 vcc, s44, v26
    v_cmp_ne_u32 s[46:47], s44, v27
    s_nop 1
    s_or_b64 vcc, vcc, s[46:47]
    s_cmp_eq_u64 vcc, 0
    s_cbranch_scc1 L_pld_33
    s_sleep 4
    s_sub_u32 s45, s45, 1
    s_cmp_lg_u32 s45, 0
    s_cbranch_scc1 L_pl_32
L_pld_33:
    v_lshlrev_b32 v15, 3, v0
    v_add_u32 v15, 66688, v15
    ds_write2_b32 v15, v16, v18 offset0:0 offset1:1
    ds_write2_b32 v15, v20, v22 offset0:128 offset1:129
    ds_add_u32 v4, v5 offset:0
    s_cmp_ge_u32 s7, 28
    s_cbranch_scc1 L_s0_nomlp
    s_mov_b32 s45, 0x100000
L_fl_34:
    ds_read_b32 v26, v4 offset:24
    s_waitcnt lgkmcnt(0)
    v_readfirstlane_b32 s46, v26
    s_nop 1
    s_cmp_ge_u32 s46, 256
    s_cbranch_scc1 L_fld_35
    s_sub_u32 s45, s45, 1
    s_cmp_lg_u32 s45, 0
    s_cbranch_scc1 L_fl_34
L_fld_35:
    s_mul_i32 s10, s4, 28
    s_add_u32 s10, s10, s7
    s_lshl_b32 s10, s10, 11
    s_add_u32 s10, s10, 720896
    v_lshlrev_b32 v14, 4, v0
    s_mov_b32 s45, 20000
L_pl_36:
    buffer_load_dwordx4 v[16:19], v14, s[60:63], s10 offen sc1
    buffer_load_dwordx4 v[20:23], v14, s[60:63], s10 offen offset:1024 sc1
    s_waitcnt vmcnt(0)
    v_min_u32 v26, v17, v19
    v_max_u32 v27, v17, v19
    v_min3_u32 v26, v26, v21, v23
    v_max3_u32 v27, v27, v21, v23
    v_cmp_ne_u32 vcc, s44, v26
    v_cmp_ne_u32 s[46:47], s44, v27
    s_nop 1
    s_or_b64 vcc, vcc, s[46:47]
    s_cmp_eq_u64 vcc, 0
    s_cbranch_scc1 L_pld_37
    s_sleep 4
    s_sub_u32 s45, s45, 1
    s_cmp_lg_u32 s45, 0
    s_cbranch_scc1 L_pl_36
L_pld_37:
    v_add_f32 v16, v16, v20
    v_add_f32 v18, v18, v22
    s_nop 0
    v_add_f32_dpp v16, v16, v16 row_ror:8 row_mask:0xf bank_mask:0xf
    v_mov_b32 v24, v16
    s_nop 1
    v_permlane16_swap_b32 v16, v24
    v_add_f32 v16, v16, v24
    v_mov_b32 v24, v16
    s_nop 1
    v_permlane32_swap_b32 v16, v24
    v_add_f32 v16, v16, v24
    v_add_f32_dpp v18, v18, v18 row_ror:8 row_mask:0xf bank_mask:0xf
    v_mov_b32 v25, v18
    s_nop 1
    v_permlane16_swap_b32 v18, v25
    v_add_f32 v18, v18, v25
    v_mov_b32 v25, v18
    s_nop 1
    v_permlane32_swap_b32 v18, v25
    v_add_f32 v18, v18, v25
    v_cvt_pk_bf16_f32 v26, v16, v18
    v_lshlrev_b32 v16, 16, v26
    v_and_b32 v18, 0xffff0000, v26
    v_lshlrev_b32 v24, 16, v52
    v_and_b32 v25, 0xffff0000, v52
    v_add_f32 v16, v16, v24
    v_add_f32 v18, v18, v25
    v_cvt_pk_bf16_f32 v26, v16, v18
    v_lshlrev_b32 v16, 16, v26
    v_and_b32 v18, 0xffff0000, v26
    v_mul_f32 v16, v16, v51
    v_mul_f32 v18, v18, v51
    v_cvt_pk_bf16_f32 v26, v16, v18
    v_lshlrev_b32 v53, 16, v26
    v_and_b32 v54, 0xffff0000, v26
L_s0_nomlp:
    s_branch L_outproj
L_s1_main:
    s_cmp_ge_u32 s9, 28
    s_cbranch_scc1 L_s1_none
    s_cmp_ge_u32 s9, 14
    s_cselect_b32 s12, 1, 0
    s_mul_i32 s13, s12, 14
    s_sub_u32 s13, s9, s13
    s_lshl_b32 s11, s8, 1
    s_add_u32 s12, s12, s11
    s_mov_b32 s68, s12
    s_mov_b32 s69, s13
    s_mul_i32 s10, s12, 100352
    s_lshl_b32 s11, s13, 6
    s_add_u32 s10, s10, s11
    s_sub_u32 s11, 1605632, s10
    s_mul_i32 s10, s68, 100352
    s_lshl_b32 s11, s69, 6
    s_add_u32 s10, s10, s11
    s_sub_u32 s11, 1605632, s10
    s_add_u32 s48, s32, s10
    s_addc_u32 s49, s33, 0
    s_mov_b32 s50, s11
    s_mov_b32 s51, 0x20000
    v_lshrrev_b32 v9, 2, v0
    v_and_b32 v10, 3, v0
    v_lshlrev_b32 v10, 4, v10
    v_mul_u32_u24 v11, 896, v9
    v_add_u32 v11, v11, v10
    s_mov_b32 s12, 0
    s_mov_b32 m0, 45056
    s_nop 0
    buffer_load_dwordx4 v11, s[48:51], s12 offen nt lds
    s_add_u32 m0, m0, 1024
    s_add_u32 s12, s12, 14336
    buffer_load_dwordx4 v11, s[48:51], s12 offen nt lds
    s_add_u32 m0, m0, 1024
    s_add_u32 s12, s12, 14336
    buffer_load_dwordx4 v11, s[48:51], s12 offen nt lds
    s_add_u32 m0, m0, 1024
    s_add_u32 s12, s12, 14336
    buffer_load_dwordx4 v11, s[48:51], s12 offen nt lds
    s_add_u32 m0, m0, 1024
    s_add_u32 s12, s12, 14336
    buffer_load_dwordx4 v11, s[48:51], s12 offen nt lds
    s_add_u32 m0, m0, 1024
    s_add_u32 s12, s12, 14336
    buffer_load_dwordx4 v11, s[48:51], s12 offen nt lds
    s_add_u32 m0, m0, 1024
    s_add_u32 s12, s12, 14336
    buffer_load_dwordx4 v11, s[48:51], s12 offen nt lds
    s_waitcnt vmcnt(0) lgkmcnt(0)
    v_lshrrev_b32 v15, 2, v2
    v_lshl_add_u32 v15, v3, 3, v15
    v_lshlrev_b32 v15, 6, v15
    v_add_u32 v15, v15, v7
    v_add_u32 v15, 45056, v15
    v_and_b32 v12, 1, v3
    v_lshrrev_b32 v11, 2, v2
    v_lshl_add_u32 v11, v12, 3, v11
    v_lshlrev_b32 v11, 6, v11
    v_add_u32 v11, v11, v7
    v_add_u32 v11, 45056, v11
    ds_read_b64_tr_b16 v[160:161], v15 offset:0
    ds_read_b64_tr_b16 v[162:163], v15 offset:256
    ds_read_b64_tr_b16 v[164:165], v15 offset:32
    ds_read_b64_tr_b16 v[166:167], v15 offset:288
    ds_read_b64_tr_b16 v[168:169], v15 offset:2048
    ds_read_b64_tr_b16 v[170:171], v15 offset:2304
    ds_read_b64_tr_b16 v[172:173], v15 offset:2080
    ds_read_b64_tr_b16 v[174:175], v15 offset:2336
    ds_read_b64_tr_b16 v[176:177], v15 offset:4096
    ds_read_b64_tr_b16 v[178:179], v15 offset:4352
    ds_read_b64_tr_b16 v[180:181], v15 offset:4128
    ds_read_b64_tr_b16 v[182:183], v15 offset:4384
    ds_read_b64_tr_b16 v[184:185], v11 offset:6144
    ds_read_b64_tr_b16 v[186:187], v11 offset:6400
    ds_read_b64_tr_b16 v[188:189], v11 offset:6176
    ds_read_b64_tr_b16 v[190:191], v11 offset:6432
    s_waitcnt lgkmcnt(0)
    s_mov_b32 s45, 0x100000
L_fl_38:
    ds_read_b32 v26, v4 offset:20
    s_waitcnt lgkmcnt(0)
    v_readfirstlane_b32 s46, v26
    s_nop 1
    s_cmp_ge_u32 s46, 256
    s_cbranch_scc1 L_fld_39
    s_sub_u32 s45, s45, 1
    s_cmp_lg_u32 s45, 0
    s_cbranch_scc1 L_fl_38
L_fld_39:
    v_mov_b32 v13, 2147418112
    v_lshrrev_b32 v9, 3, v0
    v_and_b32 v10, 7, v0
    v_mul_u32_u24 v14, 7168, v9
    v_lshl_add_u32 v14, v10, 4, v14
    v_cmp_gt_u32 vcc, 4, v10
    s_nop 1
    v_cndmask_b32 v12, v13, v14, vcc
    s_mul_i32 s10, s68, 448
    s_add_u32 s10, s10, 135168
    s_mov_b32 s14, 0x0f0f0f0f
    s_mov_b32 s15, 0x0f0f0f0f
    s_mov_b32 s45, 20000
L_pl_40:
    buffer_load_dwordx4 v[64:67], v14, s[60:63], s10 offen offset:0 sc1
    buffer_load_dwordx4 v[68:71], v14, s[60:63], s10 offen offset:128 sc1
    buffer_load_dwordx4 v[72:75], v14, s[60:63], s10 offen offset:256 sc1
    buffer_load_dwordx4 v[76:79], v12, s[60:63], s10 offen offset:384 sc1
    s_waitcnt vmcnt(0)
    v_mov_b32 v28, s44
    v_cndmask_b32 v77, v28, v77, s[14:15]
    v_cndmask_b32 v79, v28, v79, s[14:15]
    v_min_u32 v26, v65, v67
    v_max_u32 v27, v65, v67
    v_min3_u32 v26, v26, v69, v71
    v_max3_u32 v27, v27, v69, v71
    v_min3_u32 v26, v26, v73, v75
    v_max3_u32 v27, v27, v73, v75
    v_min3_u32 v26, v26, v77, v79
    v_max3_u32 v27, v27, v77, v79
    v_cmp_ne_u32 vcc, s44, v26
    v_cmp_ne_u32 s[46:47], s44, v27
    s_nop 1
    s_or_b64 vcc, vcc, s[46:47]
    s_cmp_eq_u64 vcc, 0
    s_cbranch_scc1 L_pld_41
    s_sleep 4
    s_sub_u32 s45, s45, 1
    s_cmp_lg_u32 s45, 0
    s_cbranch_scc1 L_pl_40
L_pld_41:
    v_mul_u32_u24 v15, 272, v9
    v_lshl_add_u32 v15, v10, 3, v15
    v_add_u32 v15, 73856, v15
    ds_write2_b32 v15, v64, v66 offset0:0 offset1:1
    ds_write2_b32 v15, v68, v70 offset0:16 offset1:17
    ds_write2_b32 v15, v72, v74 offset0:32 offset1:33
    ds_write2_b32 v15, v76, v78 offset0:48 offset1:49
    v_and_b32 v15, 7, v2
    v_mul_u32_u24 v15, 272, v15
    v_lshl_add_u32 v15, v3, 4, v15
    v_add_u32 v15, 73856, v15
    s_waitcnt lgkmcnt(0)
    ds_read_b128 v[128:131], v15 offset:0
    ds_read_b128 v[132:135], v15 offset:64
    ds_read_b128 v[136:139], v15 offset:128
    ds_read_b128 v[140:143], v15 offset:192
    s_waitcnt lgkmcnt(0)
    v_mfma_f32_16x16x32_bf16 v[16:19], v[128:131], v[160:163], 0
    v_mfma_f32_16x16x32_bf16 v[20:23], v[128:131], v[164:167], 0
    v_mfma_f32_16x16x32_bf16 v[16:19], v[132:135], v[168:171], v[16:19]
    v_mfma_f32_16x16x32_bf16 v[20:23], v[132:135], v[172:175], v[20:23]
    v_mfma_f32_16x16x32_bf16 v[16:19], v[136:139], v[176:179], v[16:19]
    v_mfma_f32_16x16x32_bf16 v[20:23], v[136:139], v[180:183], v[20:23]
    v_mfma_f32_16x16x32_bf16 v[16:19], v[140:143], v[184:187], v[16:19]
    v_mfma_f32_16x16x32_bf16 v[20:23], v[140:143], v[188:191], v[20:23]
    v_and_b32 v29, 1, v3
    v_mul_u32_u24 v29, 229376, v29
    v_lshrrev_b32 v28, 1, v3
    v_lshl_add_u32 v29, v28, 11, v29
    v_lshl_add_u32 v29, v2, 3, v29
    s_lshl_b32 s10, s69, 12
    s_lshl_b32 s11, s68, 7
    s_add_u32 s10, s10, s11
    s_add_u32 s10, s10, 720896
    s_mov_b32 s48, 0
    s_mov_b32 s49, -1
    v_mov_b32 v33, s44
    v_cndmask_b32 v32, v16, v20, s[48:49]
    v_mov_b32 v35, s44
    v_cndmask_b32 v34, v17, v21, s[48:49]
    v_mov_b32 v37, s44
    v_cndmask_b32 v36, v18, v22, s[48:49]
    v_mov_b32 v39, s44
    v_cndmask_b32 v38, v19, v23, s[48:49]
    s_add_u32 s11, s10, 0
    buffer_store_dwordx2 v[32:33], v29, s[60:63], s11 offen sc1
    s_add_u32 s11, s10, 57344
    buffer_store_dwordx2 v[34:35], v29, s[60:63], s11 offen sc1
    s_add_u32 s11, s10, 114688
    buffer_store_dwordx2 v[36:37], v29, s[60:63], s11 offen sc1
    s_add_u32 s11, s10, 172032
    buffer_store_dwordx2 v[38:39], v29, s[60:63], s11 offen sc1
L_s1_none:
    s_cmp_eq_u32 s4, 7
    s_cbranch_scc1 L_s1_wo
    s_lshl_b32 s10, s5, 9
    s_lshl_b32 s11, s6, 6
    s_add_u32 s10, s10, s11
    s_mul_i32 s10, s10, 896
    s_lshl_b32 s11, s4, 7
    s_add_u32 s10, s10, s11
    s_sub_u32 s11, 3670016, s10
    s_add_u32 s52, s24, s10
    s_addc_u32 s53, s25, 0
    s_mov_b32 s54, s11
    s_mov_b32 s55, 0x20000
    v_lshrrev_b32 v9, 3, v0
    v_mul_u32_u24 v9, 896, v9
    v_and_b32 v10, 7, v0
    v_lshl_add_u32 v9, v10, 4, v9
    s_mov_b32 s45, 0x100000
L_fl_42:
    ds_read_b32 v26, v4 offset:36
    s_waitcnt lgkmcnt(0)
    v_readfirstlane_b32 s46, v26
    s_nop 1
    s_cmp_ge_u32 s46, 256
    s_cbranch_scc1 L_fld_43
    s_sub_u32 s45, s45, 1
    s_cmp_lg_u32 s45, 0
    s_cbranch_scc1 L_fl_42
L_fld_43:
    s_mov_b32 m0, 0
    s_mov_b32 s12, 0
    buffer_load_dwordx4 v9, s[52:55], s12 offen nt lds
    s_add_u32 m0, m0, 1024
    s_add_u32 s12, s12, 7168
    buffer_load_dwordx4 v9, s[52:55], s12 offen nt lds
    s_add_u32 m0, m0, 1024
    s_add_u32 s12, s12, 7168
    buffer_load_dwordx4 v9, s[52:55], s12 offen nt lds
    s_add_u32 m0, m0, 1024
    s_add_u32 s12, s12, 7168
    buffer_load_dwordx4 v9, s[52:55], s12 offen nt lds
    s_add_u32 m0, m0, 1024
    s_add_u32 s12, s12, 7168
    buffer_load_dwordx4 v9, s[52:55], s12 offen nt lds
    s_add_u32 m0, m0, 1024
    s_add_u32 s12, s12, 7168
    buffer_load_dwordx4 v9, s[52:55], s12 offen nt lds
    s_add_u32 m0, m0, 1024
    s_add_u32 s12, s12, 7168
    buffer_load_dwordx4 v9, s[52:55], s12 offen nt lds
    s_add_u32 m0, m0, 1024
    s_add_u32 s12, s12, 7168
    buffer_load_dwordx4 v9, s[52:55], s12 offen nt lds
    s_add_u32 m0, m0, 1024
    s_add_u32 s12, s12, 179200
    buffer_load_dwordx4 v9, s[52:55], s12 offen nt lds
    s_add_u32 m0, m0, 1024
    s_add_u32 s12, s12, 7168
    buffer_load_dwordx4 v9, s[52:55], s12 offen nt lds
    s_add_u32 m0, m0, 1024
    s_add_u32 s12, s12, 7168
    buffer_load_dwordx4 v9, s[52:55], s12 offen nt lds
    s_add_u32 m0, m0, 1024
    s_add_u32 s12, s12, 7168
    buffer_load_dwordx4 v9, s[52:55], s12 offen nt lds
    s_add_u32 m0, m0, 1024
    s_add_u32 s12, s12, 7168
    buffer_load_dwordx4 v9, s[52:55], s12 offen nt lds
    s_add_u32 m0, m0, 1024
    s_add_u32 s12, s12, 7168
    buffer_load_dwordx4 v9, s[52:55], s12 offen nt lds
    s_add_u32 m0, m0, 1024
    s_add_u32 s12, s12, 7168
    buffer_load_dwordx4 v9, s[52:55], s12 offen nt lds
    s_add_u32 m0, m0, 1024
    s_add_u32 s12, s12, 7168
    buffer_load_dwordx4 v9, s[52:55], s12 offen nt lds
L_s1_wo:
    s_branch L_outproj
L_s3_main:
    s_waitcnt vmcnt(0)
    ds_add_u32 v4, v5 offset:28
    s_waitcnt lgkmcnt(0)
    s_mul_i32 s44, s44, 1664525
    s_add_u32 s44, s44, 1013904223
L_s3_fin:
    s_branch L_softmax
L_s2_main:
    s_waitcnt lgkmcnt(0)
    s_mul_i32 s44, s44, 1664525
    s_add_u32 s44, s44, 1013904223
    s_bitcmp0_b32 s9, 0
    s_cbranch_scc1 L_softmax
    s_cmp_ge_u32 s9, 28
    s_cbranch_scc1 L_softmax
    s_mov_b32 s45, 0x100000
L_fl_45:
    ds_read_b32 v26, v4 offset:28
    s_waitcnt lgkmcnt(0)
    v_readfirstlane_b32 s46, v26
    s_nop 1
    s_cmp_ge_u32 s46, 1
    s_cbranch_scc1 L_fld_46
    s_sub_u32 s45, s45, 1
    s_cmp_lg_u32 s45, 0
    s_cbranch_scc1 L_fl_45
L_fld_46:
    v_lshrrev_b32 v9, 3, v0
    v_and_b32 v10, 7, v0
    v_lshlrev_b32 v10, 4, v10
    v_mul_u32_u24 v11, 896, v9
    v_add_u32 v11, v11, v10
    v_add_u32 v11, 52224, v11
    ds_read_b128 v[64:67], v11 offset:0
    ds_read_b128 v[68:71], v11 offset:128
    ds_read_b128 v[72:75], v11 offset:256
    ds_read_b128 v[76:79], v11 offset:384
    ds_read_b128 v[80:83], v11 offset:512
    ds_read_b128 v[84:87], v11 offset:640
    ds_read_b128 v[88:91], v11 offset:768
    v_mul_u32_u24 v12, 912, v9
    v_add_u32 v12, v12, v10
    v_add_u32 v12, 59392, v12
    s_waitcnt lgkmcnt(0)
    ds_add_u32 v4, v5 offset:4
    v_lshlrev_b32 v128, 16, v64
    v_and_b32 v129, 0xffff0000, v64
    v_lshlrev_b32 v130, 16, v65
    v_and_b32 v131, 0xffff0000, v65
    v_lshlrev_b32 v132, 16, v66
    v_and_b32 v133, 0xffff0000, v66
    v_lshlrev_b32 v134, 16, v67
    v_and_b32 v135, 0xffff0000, v67
    v_lshlrev_b32 v136, 16, v68
    v_and_b32 v137, 0xffff0000, v68
    v_lshlrev_b32 v138, 16, v69
    v_and_b32 v139, 0xffff0000, v69
    v_lshlrev_b32 v140, 16, v70
    v_and_b32 v141, 0xffff0000, v70
    v_lshlrev_b32 v142, 16, v71
    v_and_b32 v143, 0xffff0000, v71
    v_lshlrev_b32 v144, 16, v72
    v_and_b32 v145, 0xffff0000, v72
    v_lshlrev_b32 v146, 16, v73
    v_and_b32 v147, 0xffff0000, v73
    v_lshlrev_b32 v148, 16, v74
    v_and_b32 v149, 0xffff0000, v74
    v_lshlrev_b32 v150, 16, v75
    v_and_b32 v151, 0xffff0000, v75
    v_lshlrev_b32 v152, 16, v76
    v_and_b32 v153, 0xffff0000, v76
    v_lshlrev_b32 v154, 16, v77
    v_and_b32 v155, 0xffff0000, v77
    v_lshlrev_b32 v156, 16, v78
    v_and_b32 v157, 0xffff0000, v78
    v_lshlrev_b32 v158, 16, v79
    v_and_b32 v159, 0xffff0000, v79
    v_lshlrev_b32 v160, 16, v80
    v_and_b32 v161, 0xffff0000, v80
    v_lshlrev_b32 v162, 16, v81
    v_and_b32 v163, 0xffff0000, v81
    v_lshlrev_b32 v164, 16, v82
    v_and_b32 v165, 0xffff0000, v82
    v_lshlrev_b32 v166, 16, v83
    v_and_b32 v167, 0xffff0000, v83
    v_lshlrev_b32 v168, 16, v84
    v_and_b32 v169, 0xffff0000, v84
    v_lshlrev_b32 v170, 16, v85
    v_and_b32 v171, 0xffff0000, v85
    v_lshlrev_b32 v172, 16, v86
    v_and_b32 v173, 0xffff0000, v86
    v_lshlrev_b32 v174, 16, v87
    v_and_b32 v175, 0xffff0000, v87
    v_lshlrev_b32 v176, 16, v88
    v_and_b32 v177, 0xffff0000, v88
    v_lshlrev_b32 v178, 16, v89
    v_and_b32 v179, 0xffff0000, v89
    v_lshlrev_b32 v180, 16, v90
    v_and_b32 v181, 0xffff0000, v90
    v_lshlrev_b32 v182, 16, v91
    v_and_b32 v183, 0xffff0000, v91
    v_pk_add_f32 v[16:17], v[128:129], v[130:131]
    v_pk_add_f32 v[16:17], v[16:17], v[132:133]
    v_pk_add_f32 v[16:17], v[16:17], v[134:135]
    v_pk_add_f32 v[16:17], v[16:17], v[136:137]
    v_pk_add_f32 v[16:17], v[16:17], v[138:139]
    v_pk_add_f32 v[16:17], v[16:17], v[140:141]
    v_pk_add_f32 v[16:17], v[16:17], v[142:143]
    v_pk_add_f32 v[16:17], v[16:17], v[144:145]
    v_pk_add_f32 v[16:17], v[16:17], v[146:147]
    v_pk_add_f32 v[16:17], v[16:17], v[148:149]
    v_pk_add_f32 v[16:17], v[16:17], v[150:151]
    v_pk_add_f32 v[16:17], v[16:17], v[152:153]
    v_pk_add_f32 v[16:17], v[16:17], v[154:155]
    v_pk_add_f32 v[16:17], v[16:17], v[156:157]
    v_pk_add_f32 v[16:17], v[16:17], v[158:159]
    v_pk_add_f32 v[16:17], v[16:17], v[160:161]
    v_pk_add_f32 v[16:17], v[16:17], v[162:163]
    v_pk_add_f32 v[16:17], v[16:17], v[164:165]
    v_pk_add_f32 v[16:17], v[16:17], v[166:167]
    v_pk_add_f32 v[16:17], v[16:17], v[168:169]
    v_pk_add_f32 v[16:17], v[16:17], v[170:171]
    v_pk_add_f32 v[16:17], v[16:17], v[172:173]
    v_pk_add_f32 v[16:17], v[16:17], v[174:175]
    v_pk_add_f32 v[16:17], v[16:17], v[176:177]
    v_pk_add_f32 v[16:17], v[16:17], v[178:179]
    v_pk_add_f32 v[16:17], v[16:17], v[180:181]
    v_pk_add_f32 v[16:17], v[16:17], v[182:183]
    v_add_f32 v16, v16, v17
    s_nop 1
    v_add_f32_dpp v16, v16, v16 quad_perm:[1,0,3,2] row_mask:0xf bank_mask:0xf
    s_nop 1
    v_add_f32_dpp v16, v16, v16 quad_perm:[2,3,0,1] row_mask:0xf bank_mask:0xf
    s_nop 1
    v_add_f32_dpp v16, v16, v16 row_half_mirror row_mask:0xf bank_mask:0xf
    v_mul_f32 v16, 0x3b124925, v16
    v_cvt_pk_bf16_f32 v17, v16, v16
    v_lshlrev_b32 v18, 16, v17
    v_and_b32 v19, 0xffff0000, v17
    v_sub_f32 v20, v16, v18
    v_sub_f32 v18, 0, v18
    v_mov_b32 v19, v18
    v_pk_add_f32 v[128:129], v[128:129], v[18:19]
    v_pk_add_f32 v[130:131], v[130:131], v[18:19]
    v_pk_add_f32 v[132:133], v[132:133], v[18:19]
    v_pk_add_f32 v[134:135], v[134:135], v[18:19]
    v_pk_add_f32 v[136:137], v[136:137], v[18:19]
    v_pk_add_f32 v[138:139], v[138:139], v[18:19]
    v_pk_add_f32 v[140:141], v[140:141], v[18:19]
    v_pk_add_f32 v[142:143], v[142:143], v[18:19]
    v_pk_add_f32 v[144:145], v[144:145], v[18:19]
    v_pk_add_f32 v[146:147], v[146:147], v[18:19]
    v_pk_add_f32 v[148:149], v[148:149], v[18:19]
    v_pk_add_f32 v[150:151], v[150:151], v[18:19]
    v_pk_add_f32 v[152:153], v[152:153], v[18:19]
    v_pk_add_f32 v[154:155], v[154:155], v[18:19]
    v_pk_add_f32 v[156:157], v[156:157], v[18:19]
    v_pk_add_f32 v[158:159], v[158:159], v[18:19]
    v_pk_add_f32 v[160:161], v[160:161], v[18:19]
    v_pk_add_f32 v[162:163], v[162:163], v[18:19]
    v_pk_add_f32 v[164:165], v[164:165], v[18:19]
    v_pk_add_f32 v[166:167], v[166:167], v[18:19]
    v_pk_add_f32 v[168:169], v[168:169], v[18:19]
    v_pk_add_f32 v[170:171], v[170:171], v[18:19]
    v_pk_add_f32 v[172:173], v[172:173], v[18:19]
    v_pk_add_f32 v[174:175], v[174:175], v[18:19]
    v_pk_add_f32 v[176:177], v[176:177], v[18:19]
    v_pk_add_f32 v[178:179], v[178:179], v[18:19]
    v_pk_add_f32 v[180:181], v[180:181], v[18:19]
    v_pk_add_f32 v[182:183], v[182:183], v[18:19]
    v_pk_mul_f32 v[16:17], v[128:129], v[128:129]
    v_pk_fma_f32 v[16:17], v[130:131], v[130:131], v[16:17]
    v_pk_fma_f32 v[16:17], v[132:133], v[132:133], v[16:17]
    v_pk_fma_f32 v[16:17], v[134:135], v[134:135], v[16:17]
    v_pk_fma_f32 v[16:17], v[136:137], v[136:137], v[16:17]
    v_pk_fma_f32 v[16:17], v[138:139], v[138:139], v[16:17]
    v_pk_fma_f32 v[16:17], v[140:141], v[140:141], v[16:17]
    v_pk_fma_f32 v[16:17], v[142:143], v[142:143], v[16:17]
    v_pk_fma_f32 v[16:17], v[144:145], v[144:145], v[16:17]
    v_pk_fma_f32 v[16:17], v[146:147], v[146:147], v[16:17]
    v_pk_fma_f32 v[16:17], v[148:149], v[148:149], v[16:17]
    v_pk_fma_f32 v[16:17], v[150:151], v[150:151], v[16:17]
    v_pk_fma_f32 v[16:17], v[152:153], v[152:153], v[16:17]
    v_pk_fma_f32 v[16:17], v[154:155], v[154:155], v[16:17]
    v_pk_fma_f32 v[16:17], v[156:157], v[156:157], v[16:17]
    v_pk_fma_f32 v[16:17], v[158:159], v[158:159], v[16:17]
    v_pk_fma_f32 v[16:17], v[160:161], v[160:161], v[16:17]
    v_pk_fma_f32 v[16:17], v[162:163], v[162:163], v[16:17]
    v_pk_fma_f32 v[16:17], v[164:165], v[164:165], v[16:17]
    v_pk_fma_f32 v[16:17], v[166:167], v[166:167], v[16:17]
    v_pk_fma_f32 v[16:17], v[168:169], v[168:169], v[16:17]
    v_pk_fma_f32 v[16:17], v[170:171], v[170:171], v[16:17]
    v_pk_fma_f32 v[16:17], v[172:173], v[172:173], v[16:17]
    v_pk_fma_f32 v[16:17], v[174:175], v[174:175], v[16:17]
    v_pk_fma_f32 v[16:17], v[176:177], v[176:177], v[16:17]
    v_pk_fma_f32 v[16:17], v[178:179], v[178:179], v[16:17]
    v_pk_fma_f32 v[16:17], v[180:181], v[180:181], v[16:17]
    v_pk_fma_f32 v[16:17], v[182:183], v[182:183], v[16:17]
    v_add_f32 v16, v16, v17
    s_nop 1
    v_add_f32_dpp v16, v16, v16 quad_perm:[1,0,3,2] row_mask:0xf bank_mask:0xf
    s_nop 1
    v_add_f32_dpp v16, v16, v16 quad_perm:[2,3,0,1] row_mask:0xf bank_mask:0xf
    s_nop 1
    v_add_f32_dpp v16, v16, v16 row_half_mirror row_mask:0xf bank_mask:0xf
    v_mul_f32 v16, 0x3b124925, v16
    v_fma_f32 v16, -v20, v20, v16
    v_max_f32 v16, 0, v16
    v_cvt_pk_bf16_f32 v21, v16, v16
    v_lshlrev_b32 v16, 16, v21
    v_and_b32 v17, 0xffff0000, v21
    v_add_f32 v16, 0x3727c5ac, v16
    v_cvt_pk_bf16_f32 v21, v16, v16
    v_lshlrev_b32 v16, 16, v21
    v_and_b32 v17, 0xffff0000, v21
    v_sqrt_f32 v16, v16
    s_nop 0
    v_cvt_pk_bf16_f32 v21, v16, v16
    v_lshlrev_b32 v16, 16, v21
    v_and_b32 v17, 0xffff0000, v21
    v_rcp_f32 v16, v16
    s_nop 0
    v_mov_b32 v17, v16
    v_pk_mul_f32 v[128:129], v[128:129], v[16:17]
    v_pk_mul_f32 v[130:131], v[130:131], v[16:17]
    v_pk_mul_f32 v[132:133], v[132:133], v[16:17]
    v_pk_mul_f32 v[134:135], v[134:135], v[16:17]
    v_pk_mul_f32 v[136:137], v[136:137], v[16:17]
    v_pk_mul_f32 v[138:139], v[138:139], v[16:17]
    v_pk_mul_f32 v[140:141], v[140:141], v[16:17]
    v_pk_mul_f32 v[142:143], v[142:143], v[16:17]
    v_pk_mul_f32 v[144:145], v[144:145], v[16:17]
    v_pk_mul_f32 v[146:147], v[146:147], v[16:17]
    v_pk_mul_f32 v[148:149], v[148:149], v[16:17]
    v_pk_mul_f32 v[150:151], v[150:151], v[16:17]
    v_pk_mul_f32 v[152:153], v[152:153], v[16:17]
    v_pk_mul_f32 v[154:155], v[154:155], v[16:17]
    v_pk_mul_f32 v[156:157], v[156:157], v[16:17]
    v_pk_mul_f32 v[158:159], v[158:159], v[16:17]
    v_pk_mul_f32 v[160:161], v[160:161], v[16:17]
    v_pk_mul_f32 v[162:163], v[162:163], v[16:17]
    v_pk_mul_f32 v[164:165], v[164:165], v[16:17]
    v_pk_mul_f32 v[166:167], v[166:167], v[16:17]
    v_pk_mul_f32 v[168:169], v[168:169], v[16:17]
    v_pk_mul_f32 v[170:171], v[170:171], v[16:17]
    v_pk_mul_f32 v[172:173], v[172:173], v[16:17]
    v_pk_mul_f32 v[174:175], v[174:175], v[16:17]
    v_pk_mul_f32 v[176:177], v[176:177], v[16:17]
    v_pk_mul_f32 v[178:179], v[178:179], v[16:17]
    v_pk_mul_f32 v[180:181], v[180:181], v[16:17]
    v_pk_mul_f32 v[182:183], v[182:183], v[16:17]
    v_cvt_pk_bf16_f32 v64, v128, v129
    v_cvt_pk_bf16_f32 v65, v130, v131
    v_cvt_pk_bf16_f32 v66, v132, v133
    v_cvt_pk_bf16_f32 v67, v134, v135
    v_cvt_pk_bf16_f32 v68, v136, v137
    v_cvt_pk_bf16_f32 v69, v138, v139
    v_cvt_pk_bf16_f32 v70, v140, v141
    v_cvt_pk_bf16_f32 v71, v142, v143
    v_cvt_pk_bf16_f32 v72, v144, v145
    v_cvt_pk_bf16_f32 v73, v146, v147
    v_cvt_pk_bf16_f32 v74, v148, v149
    v_cvt_pk_bf16_f32 v75, v150, v151
    v_cvt_pk_bf16_f32 v76, v152, v153
    v_cvt_pk_bf16_f32 v77, v154, v155
    v_cvt_pk_bf16_f32 v78, v156, v157
    v_cvt_pk_bf16_f32 v79, v158, v159
    v_cvt_pk_bf16_f32 v80, v160, v161
    v_cvt_pk_bf16_f32 v81, v162, v163
    v_cvt_pk_bf16_f32 v82, v164, v165
    v_cvt_pk_bf16_f32 v83, v166, v167
    v_cvt_pk_bf16_f32 v84, v168, v169
    v_cvt_pk_bf16_f32 v85, v170, v171
    v_cvt_pk_bf16_f32 v86, v172, v173
    v_cvt_pk_bf16_f32 v87, v174, v175
    v_cvt_pk_bf16_f32 v88, v176, v177
    v_cvt_pk_bf16_f32 v89, v178, v179
    v_cvt_pk_bf16_f32 v90, v180, v181
    v_cvt_pk_bf16_f32 v91, v182, v183
    ds_write_b128 v12, v[64:67] offset:0
    ds_write_b128 v12, v[68:71] offset:128
    ds_write_b128 v12, v[72:75] offset:256
    ds_write_b128 v12, v[76:79] offset:384
    ds_write_b128 v12, v[80:83] offset:512
    ds_write_b128 v12, v[84:87] offset:640
    ds_write_b128 v12, v[88:91] offset:768
    s_waitcnt vmcnt(0) lgkmcnt(0)
    v_mov_b32 v13, 2147418112
    v_and_b32 v15, 7, v2
    v_mul_u32_u24 v15, 912, v15
    v_lshl_add_u32 v15, v3, 4, v15
    v_add_u32 v15, 59392, v15
    ds_read_b128 v[64:67], v15 offset:0
    ds_read_b128 v[68:71], v15 offset:64
    ds_read_b128 v[72:75], v15 offset:128
    ds_read_b128 v[76:79], v15 offset:192
    ds_read_b128 v[80:83], v15 offset:256
    ds_read_b128 v[84:87], v15 offset:320
    ds_read_b128 v[88:91], v15 offset:384
    ds_read_b128 v[92:95], v15 offset:448
    ds_read_b128 v[96:99], v15 offset:512
    ds_read_b128 v[100:103], v15 offset:576
    ds_read_b128 v[104:107], v15 offset:640
    ds_read_b128 v[108:111], v15 offset:704
    ds_read_b128 v[112:115], v15 offset:768
    ds_read_b128 v[116:119], v15 offset:832
    v_add_u32 v15, 30720, v6
    ds_read_b64_tr_b16 v[128:129], v15 offset:0
    ds_read_b64_tr_b16 v[130:131], v15 offset:128
    ds_read_b64_tr_b16 v[132:133], v15 offset:1024
    ds_read_b64_tr_b16 v[134:135], v15 offset:1152
    ds_read_b64_tr_b16 v[136:137], v15 offset:2048
    ds_read_b64_tr_b16 v[138:139], v15 offset:2176
    ds_read_b64_tr_b16 v[140:141], v15 offset:3072
    ds_read_b64_tr_b16 v[142:143], v15 offset:3200
    ds_read_b64_tr_b16 v[144:145], v15 offset:4096
    ds_read_b64_tr_b16 v[146:147], v15 offset:4224
    ds_read_b64_tr_b16 v[148:149], v15 offset:5120
    ds_read_b64_tr_b16 v[150:151], v15 offset:5248
    ds_read_b64_tr_b16 v[152:153], v15 offset:6144
    ds_read_b64_tr_b16 v[154:155], v15 offset:6272
    ds_read_b64_tr_b16 v[156:157], v15 offset:7168
    ds_read_b64_tr_b16 v[158:159], v15 offset:7296
    ds_read_b64_tr_b16 v[160:161], v15 offset:8192
    ds_read_b64_tr_b16 v[162:163], v15 offset:8320
    ds_read_b64_tr_b16 v[164:165], v15 offset:9216
    ds_read_b64_tr_b16 v[166:167], v15 offset:9344
    ds_read_b64_tr_b16 v[168:169], v15 offset:10240
    ds_read_b64_tr_b16 v[170:171], v15 offset:10368
    ds_read_b64_tr_b16 v[172:173], v15 offset:11264
    ds_read_b64_tr_b16 v[174:175], v15 offset:11392
    ds_read_b64_tr_b16 v[176:177], v15 offset:12288
    ds_read_b64_tr_b16 v[178:179], v15 offset:12416
    ds_read_b64_tr_b16 v[180:181], v15 offset:13312
    ds_read_b64_tr_b16 v[182:183], v15 offset:13440
    s_waitcnt lgkmcnt(0)
    v_mfma_f32_16x16x32_bf16 v[16:19], v[128:131], v[64:67], 0
    v_mfma_f32_16x16x32_bf16 v[16:19], v[132:135], v[68:71], v[16:19]
    v_mfma_f32_16x16x32_bf16 v[16:19], v[136:139], v[72:75], v[16:19]
    v_mfma_f32_16x16x32_bf16 v[16:19], v[140:143], v[76:79], v[16:19]
    v_mfma_f32_16x16x32_bf16 v[16:19], v[144:147], v[80:83], v[16:19]
    v_mfma_f32_16x16x32_bf16 v[16:19], v[148:151], v[84:87], v[16:19]
    v_mfma_f32_16x16x32_bf16 v[16:19], v[152:155], v[88:91], v[16:19]
    v_mfma_f32_16x16x32_bf16 v[16:19], v[156:159], v[92:95], v[16:19]
    v_mfma_f32_16x16x32_bf16 v[16:19], v[160:163], v[96:99], v[16:19]
    v_mfma_f32_16x16x32_bf16 v[16:19], v[164:167], v[100:103], v[16:19]
    v_mfma_f32_16x16x32_bf16 v[16:19], v[168:171], v[104:107], v[16:19]
    v_mfma_f32_16x16x32_bf16 v[16:19], v[172:175], v[108:111], v[16:19]
    v_mfma_f32_16x16x32_bf16 v[16:19], v[176:179], v[112:115], v[16:19]
    v_mfma_f32_16x16x32_bf16 v[16:19], v[180:183], v[116:119], v[16:19]
    s_nop 7
    v_cvt_pk_bf16_f32 v26, v16, v17
    v_lshlrev_b32 v16, 16, v26
    v_and_b32 v17, 0xffff0000, v26
    v_cvt_pk_bf16_f32 v27, v18, v19
    v_lshlrev_b32 v18, 16, v27
    v_and_b32 v19, 0xffff0000, v27
    v_lshlrev_b32 v28, 16, v24
    v_and_b32 v29, 0xffff0000, v24
    v_lshlrev_b32 v30, 16, v25
    v_and_b32 v31, 0xffff0000, v25
    v_add_f32 v16, v16, v28
    v_add_f32 v17, v17, v29
    v_add_f32 v18, v18, v30
    v_add_f32 v19, v19, v31
    v_cvt_pk_bf16_f32 v26, v16, v17
    v_lshlrev_b32 v16, 16, v26
    v_and_b32 v17, 0xffff0000, v26
    v_cvt_pk_bf16_f32 v27, v18, v19
    v_lshlrev_b32 v18, 16, v27
    v_and_b32 v19, 0xffff0000, v27
    s_mov_b32 s10, 0xc0135761
    s_mov_b32 s11, 0xbdd2d3e8
    v_mov_b32 v32, s10
    v_mul_f32 v28, v16, v16
    v_fma_f32 v28, v28, s11, v32
    v_mul_f32 v28, v28, v16
    v_mul_f32 v29, v17, v17
    v_fma_f32 v29, v29, s11, v32
    v_mul_f32 v29, v29, v17
    v_mul_f32 v30, v18, v18
    v_fma_f32 v30, v30, s11, v32
    v_mul_f32 v30, v30, v18
    v_mul_f32 v31, v19, v19
    v_fma_f32 v31, v31, s11, v32
    v_mul_f32 v31, v31, v19
    v_exp_f32 v28, v28
    v_exp_f32 v29, v29
    v_exp_f32 v30, v30
    v_exp_f32 v31, v31
    v_add_f32 v28, 1.0, v28
    v_add_f32 v29, 1.0, v29
    v_add_f32 v30, 1.0, v30
    v_add_f32 v31, 1.0, v31
    v_rcp_f32 v28, v28
    v_rcp_f32 v29, v29
    v_rcp_f32 v30, v30
    v_rcp_f32 v31, v31
    v_mul_f32 v16, v16, v28
    v_mul_f32 v17, v17, v29
    v_mul_f32 v18, v18, v30
    v_mul_f32 v19, v19, v31
    v_cvt_pk_bf16_f32 v20, v16, v17
    v_cvt_pk_bf16_f32 v21, v18, v19
    v_lshlrev_b32 v14, 5, v2
    v_lshl_add_u32 v14, v3, 3, v14
    v_add_u32 v14, 78208, v14
    ds_write_b64 v14, v[20:21]
    v_lshlrev_b32 v14, 3, v0
    v_add_u32 v14, 78208, v14
    ds_read_b64 v[24:25], v14
    v_lshrrev_b32 v14, 2, v0
    v_mul_u32_u24 v14, 7168, v14
    v_and_b32 v15, 3, v0
    v_lshl_add_u32 v14, v15, 4, v14
    v_cmp_gt_u32 vcc, 32, v0
    s_nop 1
    v_cndmask_b32 v14, v13, v14, vcc
    s_lshl_b32 s10, s69, 6
    s_add_u32 s10, s10, 135168
    v_mov_b32 v21, s44
    v_mov_b32 v23, s44
    s_waitcnt lgkmcnt(0)
    v_mov_b32 v20, v24
    v_mov_b32 v22, v25
    buffer_store_dwordx4 v[20:23], v14, s[60:63], s10 offen sc1
    s_add_u32 s11, s10, 4194304
L_softmax:
    v_lshlrev_b32 v15, 4, v0
    v_add_u32 v15, 78208, v15
    s_cmp_eq_u32 s3, 6
    s_cbranch_scc0 L_sm_w7
    s_mov_b32 s45, 0x100000
L_fl_47:
    ds_read_b32 v26, v4 offset:24
    s_waitcnt lgkmcnt(0)
    v_readfirstlane_b32 s46, v26
    s_nop 1
    s_cmp_ge_u32 s46, 256
    s_cbranch_scc1 L_fld_48
    s_sub_u32 s45, s45, 1
    s_cmp_lg_u32 s45, 0
    s_cbranch_scc1 L_fl_47
L_fld_48:
    s_lshl_b32 s10, s4, 3
    s_add_u32 s10, s10, s5
    s_lshl_b32 s10, s10, 13
    s_add_u32 s10, s10, 196608
    s_add_u32 s11, s10, 4096
    v_lshlrev_b32 v14, 4, v0
    s_mov_b32 s45, 20000
    buffer_load_dwordx4 v[64:67], v14, s[60:63], s10 offen offset:0 sc1
    buffer_load_dwordx4 v[68:71], v14, s[60:63], s10 offen offset:1024 sc1
    buffer_load_dwordx4 v[72:75], v14, s[60:63], s10 offen offset:2048 sc1
    buffer_load_dwordx4 v[76:79], v14, s[60:63], s10 offen offset:3072 sc1
    buffer_load_dwordx4 v[80:83], v14, s[60:63], s11 offen offset:0 sc1
    buffer_load_dwordx4 v[84:87], v14, s[60:63], s11 offen offset:1024 sc1
    buffer_load_dwordx4 v[88:91], v14, s[60:63], s11 offen offset:2048 sc1
    buffer_load_dwordx4 v[92:95], v14, s[60:63], s11 offen offset:3072 sc1
    ds_add_u32 v4, v5 offset:32
    s_branch L_pl_49_w
L_pl_49:
    buffer_load_dwordx4 v[64:67], v14, s[60:63], s10 offen offset:0 sc1
    buffer_load_dwordx4 v[68:71], v14, s[60:63], s10 offen offset:1024 sc1
    buffer_load_dwordx4 v[72:75], v14, s[60:63], s10 offen offset:2048 sc1
    buffer_load_dwordx4 v[76:79], v14, s[60:63], s10 offen offset:3072 sc1
    buffer_load_dwordx4 v[80:83], v14, s[60:63], s11 offen offset:0 sc1
    buffer_load_dwordx4 v[84:87], v14, s[60:63], s11 offen offset:1024 sc1
    buffer_load_dwordx4 v[88:91], v14, s[60:63], s11 offen offset:2048 sc1
    buffer_load_dwordx4 v[92:95], v14, s[60:63], s11 offen offset:3072 sc1
L_pl_49_w:
    s_waitcnt vmcnt(0)
    v_min_u32 v26, v65, v67
    v_max_u32 v27, v65, v67
    v_min3_u32 v26, v26, v69, v71
    v_max3_u32 v27, v27, v69, v71
    v_min3_u32 v26, v26, v73, v75
    v_max3_u32 v27, v27, v73, v75
    v_min3_u32 v26, v26, v77, v79
    v_max3_u32 v27, v27, v77, v79
    v_min3_u32 v26, v26, v81, v83
    v_max3_u32 v27, v27, v81, v83
    v_min3_u32 v26, v26, v85, v87
    v_max3_u32 v27, v27, v85, v87
    v_min3_u32 v26, v26, v89, v91
    v_max3_u32 v27, v27, v89, v91
    v_min3_u32 v26, v26, v93, v95
    v_max3_u32 v27, v27, v93, v95
    v_cmp_ne_u32 vcc, s44, v26
    v_cmp_ne_u32 s[46:47], s44, v27
    s_nop 1
    s_or_b64 vcc, vcc, s[46:47]
    s_cmp_eq_u64 vcc, 0
    s_cbranch_scc1 L_pld_50
    s_sleep 4
    s_sub_u32 s45, s45, 1
    s_cmp_lg_u32 s45, 0
    s_cbranch_scc1 L_pl_49
L_pld_50:
    v_mov_b32 v96, v64
    v_mov_b32 v97, v66
    v_mov_b32 v98, v68
    v_mov_b32 v99, v70
    v_mov_b32 v100, v72
    v_mov_b32 v101, v74
    v_mov_b32 v102, v76
    v_mov_b32 v103, v78
    v_mov_b32 v104, v80
    v_mov_b32 v105, v82
    v_mov_b32 v106, v84
    v_mov_b32 v107, v86
    v_mov_b32 v108, v88
    v_mov_b32 v109, v90
    v_mov_b32 v110, v92
    v_mov_b32 v111, v94
    ds_write_b128 v15, v[96:99] offset:0
    ds_write_b128 v15, v[100:103] offset:1024
    ds_write_b128 v15, v[104:107] offset:2048
    ds_write_b128 v15, v[108:111] offset:3072
    ds_add_u32 v4, v5 offset:40
    s_branch L_sm_go
L_sm_w7:
    s_mov_b32 s45, 0x100000
L_fl_51:
    ds_read_b32 v26, v4 offset:20
    s_waitcnt lgkmcnt(0)
    v_readfirstlane_b32 s46, v26
    s_nop 1
    s_cmp_ge_u32 s46, 256
    s_cbranch_scc1 L_fld_52
    s_sub_u32 s45, s45, 1
    s_cmp_lg_u32 s45, 0
    s_cbranch_scc1 L_fl_51
L_fld_52:
    s_getreg_b32 s67, hwreg(HW_REG_XCC_ID)
    s_lshl_b32 s15, s8, 9
    s_add_u32 s15, s15, 2228224
    v_mov_b32 v13, 2147418112
    v_lshlrev_b32 v19, 3, v0
    v_cmp_gt_u32 vcc, 32, v0
    s_nop 1
    v_cndmask_b32 v19, v13, v19, vcc
    s_mov_b32 s45, 4
L_dc_53:
    buffer_load_dwordx2 v[20:21], v19, s[60:63], s15 offen sc1
    s_waitcnt vmcnt(0)
    v_cmp_ne_u32 vcc, s44, v21
    s_nop 1
    s_cmp_eq_u32 vcc_lo, 0
    s_cbranch_scc1 L_dco_55
    s_sleep 2
    s_sub_u32 s45, s45, 1
    s_cmp_lg_u32 s45, 0
    s_cbranch_scc1 L_dc_53
    s_branch L_dcd_54
L_dco_55:
    v_cmp_ne_u32 vcc, s67, v20
    s_nop 1
    s_cmp_eq_u32 vcc_lo, 0
    s_cbranch_scc0 L_dcd_54
    ds_add_u32 v4, v5 offset:44
L_dcd_54:
    ds_add_u32 v4, v5 offset:44
    s_mov_b32 s45, 0x100000
L_fl_56:
    ds_read_b32 v26, v4 offset:40
    s_waitcnt lgkmcnt(0)
    v_readfirstlane_b32 s46, v26
    s_nop 1
    s_cmp_ge_u32 s46, 1
    s_cbranch_scc1 L_fld_57
    s_sub_u32 s45, s45, 1
    s_cmp_lg_u32 s45, 0
    s_cbranch_scc1 L_fl_56
L_fld_57:
    ds_read_b128 v[96:99], v15 offset:0
    ds_read_b128 v[100:103], v15 offset:1024
    ds_read_b128 v[104:107], v15 offset:2048
    ds_read_b128 v[108:111], v15 offset:3072
    s_waitcnt lgkmcnt(0)
L_sm_go:
    s_mov_b32 s12, 0x01000c0c
    s_cmp_eq_u32 s3, 6
    s_cselect_b32 s12, s12, 0x03020c0c
    v_perm_b32 v128, v96, v96, s12
    v_perm_b32 v129, v97, v97, s12
    v_perm_b32 v130, v98, v98, s12
    v_perm_b32 v131, v99, v99, s12
    v_perm_b32 v132, v100, v100, s12
    v_perm_b32 v133, v101, v101, s12
    v_perm_b32 v134, v102, v102, s12
    v_perm_b32 v135, v103, v103, s12
    v_perm_b32 v136, v104, v104, s12
    v_perm_b32 v137, v105, v105, s12
    v_perm_b32 v138, v106, v106, s12
    v_perm_b32 v139, v107, v107, s12
    v_perm_b32 v140, v108, v108, s12
    v_perm_b32 v141, v109, v109, s12
    v_perm_b32 v142, v110, v110, s12
    v_perm_b32 v143, v111, v111, s12
    v_max3_f32 v16, v128, v129, v130
    v_max3_f32 v16, v16, v131, v132
    v_max3_f32 v16, v16, v133, v134
    v_max3_f32 v16, v16, v135, v136
    v_max3_f32 v16, v16, v137, v138
    v_max3_f32 v16, v16, v139, v140
    v_max3_f32 v16, v16, v141, v142
    v_max_f32 v16, v16, v143
    s_nop 1
    v_max_f32_dpp v16, v16, v16 quad_perm:[1,0,3,2] row_mask:0xf bank_mask:0xf
    s_nop 1
    v_max_f32_dpp v16, v16, v16 quad_perm:[2,3,0,1] row_mask:0xf bank_mask:0xf
    s_nop 1
    v_max_f32_dpp v16, v16, v16 row_half_mirror row_mask:0xf bank_mask:0xf
    s_nop 1
    v_max_f32_dpp v16, v16, v16 row_mirror row_mask:0xf bank_mask:0xf
    v_mov_b32 v17, v16
    s_nop 1
    v_permlane16_swap_b32 v16, v17
    v_max_f32 v16, v16, v17
    v_mov_b32 v17, v16
    s_nop 1
    v_permlane32_swap_b32 v16, v17
    v_max_f32 v16, v16, v17
    s_mov_b32 s13, 0x3db8aa3b
    v_mul_f32 v16, s13, v16
    v_sub_f32 v16, 0, v16
    v_fma_f32 v128, v128, s13, v16
    v_fma_f32 v129, v129, s13, v16
    v_fma_f32 v130, v130, s13, v16
    v_fma_f32 v131, v131, s13, v16
    v_fma_f32 v132, v132, s13, v16
    v_fma_f32 v133, v133, s13, v16
    v_fma_f32 v134, v134, s13, v16
    v_fma_f32 v135, v135, s13, v16
    v_fma_f32 v136, v136, s13, v16
    v_fma_f32 v137, v137, s13, v16
    v_fma_f32 v138, v138, s13, v16
    v_fma_f32 v139, v139, s13, v16
    v_fma_f32 v140, v140, s13, v16
    v_fma_f32 v141, v141, s13, v16
    v_fma_f32 v142, v142, s13, v16
    v_fma_f32 v143, v143, s13, v16
    v_exp_f32 v128, v128
    v_exp_f32 v129, v129
    v_exp_f32 v130, v130
    v_exp_f32 v131, v131
    v_exp_f32 v132, v132
    v_exp_f32 v133, v133
    v_exp_f32 v134, v134
    v_exp_f32 v135, v135
    v_exp_f32 v136, v136
    v_exp_f32 v137, v137
    v_exp_f32 v138, v138
    v_exp_f32 v139, v139
    v_exp_f32 v140, v140
    v_exp_f32 v141, v141
    v_exp_f32 v142, v142
    v_exp_f32 v143, v143
    v_add_f32 v17, v128, v129
    v_add_f32 v18, v130, v131
    v_add_f32 v17, v17, v132
    v_add_f32 v18, v18, v133
    v_add_f32 v17, v17, v134
    v_add_f32 v18, v18, v135
    v_add_f32 v17, v17, v136
    v_add_f32 v18, v18, v137
    v_add_f32 v17, v17, v138
    v_add_f32 v18, v18, v139
    v_add_f32 v17, v17, v140
    v_add_f32 v18, v18, v141
    v_add_f32 v17, v17, v142
    v_add_f32 v18, v18, v143
    v_add_f32 v17, v17, v18
    s_nop 1
    v_add_f32_dpp v17, v17, v17 quad_perm:[1,0,3,2] row_mask:0xf bank_mask:0xf
    s_nop 1
    v_add_f32_dpp v17, v17, v17 quad_perm:[2,3,0,1] row_mask:0xf bank_mask:0xf
    s_nop 1
    v_add_f32_dpp v17, v17, v17 row_half_mirror row_mask:0xf bank_mask:0xf
    s_nop 1
    v_add_f32_dpp v17, v17, v17 row_mirror row_mask:0xf bank_mask:0xf
    v_mov_b32 v18, v17
    s_nop 1
    v_permlane16_swap_b32 v17, v18
    v_add_f32 v17, v17, v18
    v_mov_b32 v18, v17
    s_nop 1
    v_permlane32_swap_b32 v17, v18
    v_add_f32 v17, v17, v18
    v_rcp_f32 v17, v17
    s_nop 0
    v_mul_f32 v128, v128, v17
    v_mul_f32 v129, v129, v17
    v_mul_f32 v130, v130, v17
    v_mul_f32 v131, v131, v17
    v_mul_f32 v132, v132, v17
    v_mul_f32 v133, v133, v17
    v_mul_f32 v134, v134, v17
    v_mul_f32 v135, v135, v17
    v_mul_f32 v136, v136, v17
    v_mul_f32 v137, v137, v17
    v_mul_f32 v138, v138, v17
    v_mul_f32 v139, v139, v17
    v_mul_f32 v140, v140, v17
    v_mul_f32 v141, v141, v17
    v_mul_f32 v142, v142, v17
    v_mul_f32 v143, v143, v17
    v_cvt_pk_bf16_f32 v64, v128, v129
    v_cvt_pk_bf16_f32 v65, v130, v131
    v_cvt_pk_bf16_f32 v66, v132, v133
    v_cvt_pk_bf16_f32 v67, v134, v135
    v_cvt_pk_bf16_f32 v68, v136, v137
    v_cvt_pk_bf16_f32 v69, v138, v139
    v_cvt_pk_bf16_f32 v70, v140, v141
    v_cvt_pk_bf16_f32 v71, v142, v143
    s_sub_u32 s12, s3, 6
    s_lshl_b32 s12, s12, 11
    s_add_u32 s12, s12, 67712
    v_lshlrev_b32 v15, 2, v0
    v_add_u32 v15, s12, v15
    ds_write_b32 v15, v64 offset:0
    ds_write_b32 v15, v65 offset:256
    ds_write_b32 v15, v66 offset:512
    ds_write_b32 v15, v67 offset:768
    ds_write_b32 v15, v68 offset:1024
    ds_write_b32 v15, v69 offset:1280
    ds_write_b32 v15, v70 offset:1536
    ds_write_b32 v15, v71 offset:1792
    ds_add_u32 v4, v5 offset:12
L_outproj:
    s_cmp_eq_u32 s3, 5
    s_cbranch_scc1 L_s1_tail
    s_cmp_ge_u32 s3, 6
    s_cbranch_scc1 L_s23_end
    v_lshrrev_b32 v8, 2, v2
    v_lshl_add_u32 v8, v3, 3, v8
    v_lshlrev_b32 v8, 7, v8
    v_add_u32 v8, v8, v7
    v_mov_b32 v13, 2147418112
    v_lshlrev_b32 v10, 4, v0
    s_lshl_b32 s10, s7, 12
    s_add_u32 s10, s10, 2097152
    s_lshl_b32 s11, s4, 9
    v_add_u32 v11, s11, v10
    v_cmp_gt_u32 vcc, 32, v0
    s_nop 1
    v_cndmask_b32 v11, v13, v11, vcc
    v_and_b32 v12, 31, v0
    v_lshlrev_b32 v12, 4, v12
    v_add_u32 v12, 71808, v12
    v_lshrrev_b32 v9, 5, v0
    v_mul_u32_u24 v9, 272, v9
    v_and_b32 v15, 31, v0
    v_lshl_add_u32 v9, v15, 3, v9
    v_add_u32 v9, 76032, v9
    v_and_b32 v15, 7, v2
    v_mul_u32_u24 v15, 272, v15
    v_lshl_add_u32 v15, v3, 4, v15
    v_add_u32 v15, 76032, v15
    v_and_b32 v14, 1, v3
    v_mul_u32_u24 v14, 458752, v14
    v_lshrrev_b32 v16, 1, v3
    v_lshl_add_u32 v14, v16, 12, v14
    v_lshl_add_u32 v14, v2, 3, v14
    s_lshl_b32 s11, s4, 14
    s_lshl_b32 s13, s7, 7
    s_add_u32 s11, s11, s13
    s_add_u32 s11, s11, 1179648
    s_mov_b32 s48, 0
    s_mov_b32 s49, -1
    v_mov_b32 v193, s44
    v_mov_b32 v195, s44
    v_mov_b32 v197, s44
    v_mov_b32 v199, s44
    v_mov_b32 v201, s44
    v_mov_b32 v203, s44
    v_mov_b32 v205, s44
    v_mov_b32 v207, s44
    v_mov_b32 v57, s44
    v_mov_b32 v59, s44
    v_mov_b32 v60, v50
    v_mov_b32 v61, v53
    v_mov_b32 v62, v54
    v_mov_b32 v63, 0
    v_lshlrev_b32 v16, 4, v0
    v_add_u32 v16, 83328, v16
    s_mov_b64 exec, 0xff
    ds_write_b128 v16, v[60:63]
    s_mov_b64 exec, -1
    ds_read_b32 v26, v4 offset:44
    s_waitcnt lgkmcnt(0)
    v_readfirstlane_b32 s41, v26
    s_nop 1
    s_cmp_ge_u32 s41, 128
    s_cselect_b32 s41, 15, 1
    s_waitcnt lgkmcnt(0)
    s_barrier
    ds_read_b128 v[64:67], v12 offset:0
    ds_read_b128 v[68:71], v12 offset:512
    ds_read_b128 v[72:75], v12 offset:1024
    ds_read_b128 v[76:79], v12 offset:1536
    s_waitcnt lgkmcnt(2)
    v_pk_add_f32 v[64:65], v[64:65], v[68:69]
    v_pk_add_f32 v[66:67], v[66:67], v[70:71]
    s_waitcnt lgkmcnt(0)
    v_pk_add_f32 v[72:73], v[72:73], v[76:77]
    v_pk_add_f32 v[74:75], v[74:75], v[78:79]
    v_pk_add_f32 v[64:65], v[64:65], v[72:73]
    v_pk_add_f32 v[66:67], v[66:67], v[74:75]
    v_cvt_pk_bf16_f32 v56, v64, v65
    v_cvt_pk_bf16_f32 v58, v66, v67
    buffer_store_dwordx4 v[56:59], v11, s[60:63], s10 offen
    s_cmp_eq_u32 s4, 7
    s_cbranch_scc1 L_noproj
    s_mov_b32 s45, 20000
    s_mov_b32 s64, 0
    buffer_load_dwordx4 v[64:67], v10, s[60:63], s10 offen offset:0 sc1
    buffer_load_dwordx4 v[68:71], v10, s[60:63], s10 offen offset:1024 sc1
    buffer_load_dwordx4 v[72:75], v10, s[60:63], s10 offen offset:2048 sc1
    buffer_load_dwordx4 v[76:79], v10, s[60:63], s10 offen offset:3072 sc1
    s_mov_b32 s40, 0x100000
L_fl_60:
    ds_read_b32 v28, v4 offset:16
    s_waitcnt lgkmcnt(0)
    v_readfirstlane_b32 s46, v28
    s_nop 1
    s_cmp_ge_u32 s46, 1
    s_cbranch_scc1 L_fld_61
    s_sub_u32 s40, s40, 1
    s_cmp_lg_u32 s40, 0
    s_cbranch_scc1 L_fl_60
L_fld_61:
    ds_read_b64_tr_b16 v[128:129], v8 offset:0
    ds_read_b64_tr_b16 v[130:131], v8 offset:512
    ds_read_b64_tr_b16 v[132:133], v8 offset:32
    ds_read_b64_tr_b16 v[134:135], v8 offset:544
    ds_read_b64_tr_b16 v[136:137], v8 offset:64
    ds_read_b64_tr_b16 v[138:139], v8 offset:576
    ds_read_b64_tr_b16 v[140:141], v8 offset:96
    ds_read_b64_tr_b16 v[142:143], v8 offset:608
    ds_read_b64_tr_b16 v[144:145], v8 offset:4096
    ds_read_b64_tr_b16 v[146:147], v8 offset:4608
    ds_read_b64_tr_b16 v[148:149], v8 offset:4128
    ds_read_b64_tr_b16 v[150:151], v8 offset:4640
    ds_read_b64_tr_b16 v[152:153], v8 offset:4160
    ds_read_b64_tr_b16 v[154:155], v8 offset:4672
    ds_read_b64_tr_b16 v[156:157], v8 offset:4192
    ds_read_b64_tr_b16 v[158:159], v8 offset:4704
    ds_read_b64_tr_b16 v[160:161], v8 offset:8192
    ds_read_b64_tr_b16 v[162:163], v8 offset:8704
    ds_read_b64_tr_b16 v[164:165], v8 offset:8224
    ds_read_b64_tr_b16 v[166:167], v8 offset:8736
    ds_read_b64_tr_b16 v[168:169], v8 offset:8256
    ds_read_b64_tr_b16 v[170:171], v8 offset:8768
    ds_read_b64_tr_b16 v[172:173], v8 offset:8288
    ds_read_b64_tr_b16 v[174:175], v8 offset:8800
    ds_read_b64_tr_b16 v[176:177], v8 offset:12288
    ds_read_b64_tr_b16 v[178:179], v8 offset:12800
    ds_read_b64_tr_b16 v[180:181], v8 offset:12320
    ds_read_b64_tr_b16 v[182:183], v8 offset:12832
    ds_read_b64_tr_b16 v[184:185], v8 offset:12352
    ds_read_b64_tr_b16 v[186:187], v8 offset:12864
    ds_read_b64_tr_b16 v[188:189], v8 offset:12384
    ds_read_b64_tr_b16 v[190:191], v8 offset:12896
    s_branch L_pl_58_w
L_pl_58:
    buffer_load_dwordx4 v[64:67], v10, s[60:63], s10 offen offset:0 sc1
    buffer_load_dwordx4 v[68:71], v10, s[60:63], s10 offen offset:1024 sc1
    buffer_load_dwordx4 v[72:75], v10, s[60:63], s10 offen offset:2048 sc1
    buffer_load_dwordx4 v[76:79], v10, s[60:63], s10 offen offset:3072 sc1
L_pl_58_w:
    s_waitcnt vmcnt(0)
    v_min_u32 v26, v65, v67
    v_max_u32 v27, v65, v67
    v_min3_u32 v26, v26, v69, v71
    v_max3_u32 v27, v27, v69, v71
    v_min3_u32 v26, v26, v73, v75
    v_max3_u32 v27, v27, v73, v75
    v_min3_u32 v26, v26, v77, v79
    v_max3_u32 v27, v27, v77, v79
    v_cmp_ne_u32 vcc, s44, v26
    v_cmp_ne_u32 s[46:47], s44, v27
    s_nop 1
    s_or_b64 vcc, vcc, s[46:47]
    s_cmp_eq_u64 vcc, 0
    s_cbranch_scc1 L_pld_59
    s_sub_u32 s45, s45, 1
    s_and_b32 s65, s45, s41
    s_cmp_eq_u32 s65, 0
    s_cselect_b32 s65, 4194304, 0
    s_sub_u32 s66, s65, s64
    s_mov_b32 s64, s65
    s_add_u32 s10, s10, s66
    s_cmp_lg_u32 s45, 0
    s_cbranch_scc1 L_pl_58
L_pld_59:
    ds_write2_b32 v9, v64, v66 offset0:0 offset1:1
    ds_write2_b32 v9, v68, v70 offset0:136 offset1:137
    v_add_u32 v9, 1088, v9
    ds_write2_b32 v9, v72, v74 offset0:0 offset1:1
    ds_write2_b32 v9, v76, v78 offset0:136 offset1:137
    s_waitcnt lgkmcnt(0)
    ds_read_b128 v[96:99], v15 offset:0
    ds_read_b128 v[100:103], v15 offset:64
    ds_read_b128 v[104:107], v15 offset:128
    ds_read_b128 v[108:111], v15 offset:192
    s_waitcnt lgkmcnt(3)
    v_mfma_f32_16x16x32_bf16 v[16:19], v[96:99], v[128:131], 0
    v_mfma_f32_16x16x32_bf16 v[20:23], v[96:99], v[132:135], 0
    v_mfma_f32_16x16x32_bf16 v[24:27], v[96:99], v[136:139], 0
    v_mfma_f32_16x16x32_bf16 v[28:31], v[96:99], v[140:143], 0
    s_waitcnt lgkmcnt(2)
    v_mfma_f32_16x16x32_bf16 v[16:19], v[100:103], v[144:147], v[16:19]
    v_mfma_f32_16x16x32_bf16 v[20:23], v[100:103], v[148:151], v[20:23]
    v_mfma_f32_16x16x32_bf16 v[24:27], v[100:103], v[152:155], v[24:27]
    v_mfma_f32_16x16x32_bf16 v[28:31], v[100:103], v[156:159], v[28:31]
    s_waitcnt lgkmcnt(1)
    v_mfma_f32_16x16x32_bf16 v[16:19], v[104:107], v[160:163], v[16:19]
    v_mfma_f32_16x16x32_bf16 v[20:23], v[104:107], v[164:167], v[20:23]
    v_mfma_f32_16x16x32_bf16 v[24:27], v[104:107], v[168:171], v[24:27]
    v_mfma_f32_16x16x32_bf16 v[28:31], v[104:107], v[172:175], v[28:31]
    s_waitcnt lgkmcnt(0)
    v_mfma_f32_16x16x32_bf16 v[16:19], v[108:111], v[176:179], v[16:19]
    v_mfma_f32_16x16x32_bf16 v[20:23], v[108:111], v[180:183], v[20:23]
    v_mfma_f32_16x16x32_bf16 v[24:27], v[108:111], v[184:187], v[24:27]
    v_mfma_f32_16x16x32_bf16 v[28:31], v[108:111], v[188:191], v[28:31]
    s_nop 5
    v_cndmask_b32 v192, v16, v20, s[48:49]
    v_cndmask_b32 v194, v17, v21, s[48:49]
    v_cndmask_b32 v196, v18, v22, s[48:49]
    v_cndmask_b32 v198, v19, v23, s[48:49]
    s_add_u32 s13, s11, 0
    buffer_store_dwordx2 v[192:193], v14, s[60:63], s13 offen sc1
    s_add_u32 s13, s11, 114688
    buffer_store_dwordx2 v[194:195], v14, s[60:63], s13 offen sc1
    s_add_u32 s13, s11, 229376
    buffer_store_dwordx2 v[196:197], v14, s[60:63], s13 offen sc1
    s_add_u32 s13, s11, 344064
    buffer_store_dwordx2 v[198:199], v14, s[60:63], s13 offen sc1
    v_cndmask_b32 v200, v24, v28, s[48:49]
    v_cndmask_b32 v202, v25, v29, s[48:49]
    v_cndmask_b32 v204, v26, v30, s[48:49]
    v_cndmask_b32 v206, v27, v31, s[48:49]
    s_add_u32 s13, s11, 8192
    buffer_store_dwordx2 v[200:201], v14, s[60:63], s13 offen sc1
    s_add_u32 s13, s11, 122880
    buffer_store_dwordx2 v[202:203], v14, s[60:63], s13 offen sc1
    s_add_u32 s13, s11, 237568
    buffer_store_dwordx2 v[204:205], v14, s[60:63], s13 offen sc1
    s_add_u32 s13, s11, 352256
    buffer_store_dwordx2 v[206:207], v14, s[60:63], s13 offen sc1
L_noproj:
    ds_add_u32 v4, v5 offset:52
    s_branch L_sdone
L_s1_tail:
    v_mov_b32 v13, 2147418112
    v_lshlrev_b32 v10, 4, v0
    s_lshl_b32 s10, s7, 12
    s_add_u32 s10, s10, 6291456
    s_lshl_b32 s11, s4, 9
    v_add_u32 v11, s11, v10
    v_cmp_gt_u32 vcc, 32, v0
    s_nop 1
    v_cndmask_b32 v11, v13, v11, vcc
    v_and_b32 v12, 31, v0
    v_lshlrev_b32 v12, 4, v12
    v_add_u32 v12, 71808, v12
    v_mov_b32 v57, s44
    v_mov_b32 v59, s44
    s_mul_i32 s12, s4, 28
    s_add_u32 s12, s12, s7
    s_lshl_b32 s12, s12, 12
    s_add_u32 s12, s12, 1179648
    v_lshlrev_b32 v14, 4, v0
    v_and_b32 v15, 7, v0
    v_lshlrev_b32 v15, 4, v15
    v_add_u32 v15, 83328, v15
    s_mov_b32 s48, s38
    s_mov_b32 s49, s39
    s_mov_b32 s50, 7168
    s_mov_b32 s51, 0x20000
    v_lshlrev_b32 v9, 2, v0
    v_cmp_gt_u32 vcc, 8, v0
    s_nop 1
    v_cndmask_b32 v9, v13, v9, vcc
    s_mul_i32 s13, s4, 896
    s_lshl_b32 s14, s7, 5
    s_add_u32 s13, s13, s14
    s_waitcnt lgkmcnt(0)
    s_barrier
    s_waitcnt vmcnt(0)
    ds_add_u32 v4, v5 offset:16
    s_mov_b32 s45, 0x100000
L_fl_63:
    ds_read_b32 v26, v4 offset:44
    s_waitcnt lgkmcnt(0)
    v_readfirstlane_b32 s46, v26
    s_nop 1
    s_cmp_ge_u32 s46, 64
    s_cbranch_scc1 L_fld_64
    s_sub_u32 s45, s45, 1
    s_cmp_lg_u32 s45, 0
    s_cbranch_scc1 L_fl_63
L_fld_64:
    s_cmp_ge_u32 s46, 128
    s_cbranch_scc1 L_loc_62
    ds_read_b128 v[64:67], v12 offset:0
    ds_read_b128 v[68:71], v12 offset:512
    ds_read_b128 v[72:75], v12 offset:1024
    ds_read_b128 v[76:79], v12 offset:1536
    s_waitcnt lgkmcnt(0)
    v_pk_add_f32 v[64:65], v[64:65], v[68:69]
    v_pk_add_f32 v[66:67], v[66:67], v[70:71]
    v_pk_add_f32 v[72:73], v[72:73], v[76:77]
    v_pk_add_f32 v[74:75], v[74:75], v[78:79]
    v_pk_add_f32 v[64:65], v[64:65], v[72:73]
    v_pk_add_f32 v[66:67], v[66:67], v[74:75]
    v_cvt_pk_bf16_f32 v56, v64, v65
    v_cvt_pk_bf16_f32 v58, v66, v67
    buffer_store_dwordx4 v[56:59], v11, s[60:63], s10 offen sc1
    s_waitcnt vmcnt(0)
L_loc_62:
    s_cmp_ge_u32 s7, 28
    s_cbranch_scc1 L_sdone
    ds_read_b128 v[48:51], v15
    s_mov_b32 s45, 0x100000
L_fl_65:
    ds_read_b32 v26, v4 offset:52
    s_waitcnt lgkmcnt(0)
    v_readfirstlane_b32 s46, v26
    s_nop 1
    s_cmp_ge_u32 s46, 1
    s_cbranch_scc1 L_fld_66
    s_sub_u32 s45, s45, 1
    s_cmp_lg_u32 s45, 0
    s_cbranch_scc1 L_fl_65
L_fld_66:
    s_mov_b32 s45, 20000
    buffer_load_dwordx4 v[64:67], v14, s[60:63], s12 offen offset:0 sc1
    buffer_load_dwordx4 v[68:71], v14, s[60:63], s12 offen offset:1024 sc1
    buffer_load_dwordx4 v[72:75], v14, s[60:63], s12 offen offset:2048 sc1
    buffer_load_dwordx4 v[76:79], v14, s[60:63], s12 offen offset:3072 sc1
L_fin_loop:
    s_waitcnt vmcnt(0)
    v_cmp_ne_u32 s[16:17], s44, v65
    v_cmp_ne_u32 s[18:19], s44, v67
    v_cmp_ne_u32 s[20:21], s44, v69
    v_cmp_ne_u32 s[22:23], s44, v71
    v_cmp_ne_u32 s[24:25], s44, v73
    v_cmp_ne_u32 s[26:27], s44, v75
    v_cmp_ne_u32 s[28:29], s44, v77
    v_cmp_ne_u32 s[30:31], s44, v79
    s_or_b64 s[16:17], s[16:17], s[18:19]
    s_or_b64 s[20:21], s[20:21], s[22:23]
    s_or_b64 s[24:25], s[24:25], s[26:27]
    s_or_b64 s[28:29], s[28:29], s[30:31]
    s_or_b64 s[18:19], s[16:17], s[20:21]
    s_or_b64 s[22:23], s[24:25], s[28:29]
    s_or_b64 s[18:19], s[18:19], s[22:23]
    s_cbranch_scc0 L_fin_ok
    s_mov_b64 exec, s[16:17]
    s_cbranch_execz L_fm_67
    buffer_load_dwordx4 v[64:67], v14, s[60:63], s12 offen offset:0 sc1
L_fm_67:
    s_mov_b64 exec, s[20:21]
    s_cbranch_execz L_fm_68
    buffer_load_dwordx4 v[68:71], v14, s[60:63], s12 offen offset:1024 sc1
L_fm_68:
    s_mov_b64 exec, s[24:25]
    s_cbranch_execz L_fm_69
    buffer_load_dwordx4 v[72:75], v14, s[60:63], s12 offen offset:2048 sc1
L_fm_69:
    s_mov_b64 exec, s[28:29]
    s_cbranch_execz L_fm_70
    buffer_load_dwordx4 v[76:79], v14, s[60:63], s12 offen offset:3072 sc1
L_fm_70:
    s_mov_b64 exec, -1
    s_sub_u32 s45, s45, 1
    s_cmp_lg_u32 s45, 0
    s_cbranch_scc1 L_fin_loop
    s_waitcnt vmcnt(0)
L_fin_ok:
    v_add_f32 v16, v64, v68
    v_add_f32 v18, v66, v70
    v_add_f32 v17, v72, v76
    v_add_f32 v19, v74, v78
L_fin_sum:
    v_add_f32 v16, v16, v17
    v_add_f32 v18, v18, v19
    s_nop 0
    v_add_f32_dpp v16, v16, v16 row_ror:8 row_mask:0xf bank_mask:0xf
    v_mov_b32 v24, v16
    s_nop 1
    v_permlane16_swap_b32 v16, v24
    v_add_f32 v16, v16, v24
    v_mov_b32 v24, v16
    s_nop 1
    v_permlane32_swap_b32 v16, v24
    v_add_f32 v16, v16, v24
    v_add_f32_dpp v18, v18, v18 row_ror:8 row_mask:0xf bank_mask:0xf
    v_mov_b32 v25, v18
    s_nop 1
    v_permlane16_swap_b32 v18, v25
    v_add_f32 v18, v18, v25
    v_mov_b32 v25, v18
    s_nop 1
    v_permlane32_swap_b32 v18, v25
    v_add_f32 v18, v18, v25
    v_cvt_pk_bf16_f32 v26, v16, v18
    v_lshlrev_b32 v16, 16, v26
    v_and_b32 v18, 0xffff0000, v26
    s_waitcnt lgkmcnt(0)
    v_mul_f32 v16, v16, v48
    v_mul_f32 v18, v18, v48
    v_cvt_pk_bf16_f32 v26, v16, v18
    v_lshlrev_b32 v16, 16, v26
    v_and_b32 v18, 0xffff0000, v26
    v_add_f32 v16, v16, v49
    v_add_f32 v18, v18, v50
    v_cvt_pk_bf16_f32 v16, v16, v18
    buffer_store_dword v16, v9, s[48:51], s13 offen
    s_cmp_eq_u32 s2, 0
    s_cbranch_scc0 L_sdone
    v_mov_b32 v16, s44
    v_mov_b32 v14, 0
    v_cmp_eq_u32 vcc, 0, v0
    s_nop 1
    v_cndmask_b32 v14, v13, v14, vcc
    buffer_store_dword v16, v14, s[60:63], 0 offen sc1
    s_branch L_sdone
L_s23_end:
    s_barrier
L_sdone:
L_end:
    s_endpgm
.section .rodata,"a"
.p2align 6
.amdhsa_kernel gated_mix__sliding_block_cached__mixer_channel_mlp__decode_kernel
  .amdhsa_next_free_vgpr 256
  .amdhsa_next_free_sgpr 102
  .amdhsa_accum_offset 256
  .amdhsa_group_segment_fixed_size 0
  .amdhsa_kernarg_size 112
  .amdhsa_user_sgpr_count 2
  .amdhsa_user_sgpr_kernarg_segment_ptr 1
  .amdhsa_system_sgpr_workgroup_id_x 1
.end_amdhsa_kernel
```
